```python
import torch

def _softmax(x, axis=-1):
    return torch.softmax(x, dim=axis)
def _gelu(x):
    return torch.nn.functional.gelu(x, approximate="tanh")
def _silu(x):
    return torch.nn.functional.silu(x)
def _sigmoid(x):
    return torch.sigmoid(x)
def _layernorm(x, axis=-1, eps=1e-5):
    m = x.mean(dim=axis, keepdim=True)
    v = x.var(dim=axis, keepdim=True, unbiased=False)
    return (x - m) / torch.sqrt(v + eps)
def _scatter_add(tgt, idx, src, axis=0):
    return tgt.clone().index_add_(axis, idx, src)
def _segment_sum(src, seg, n):
    out = torch.zeros((n,) + src.shape[1:], dtype=src.dtype)
    return out.index_add_(0, seg, src)
def _pad(x, pw):
    flat = tuple(v for pair in reversed(pw) for v in pair)
    return torch.nn.functional.pad(x, flat)

kernel_name = 'concat_heads__gqa_block_cached__gqa_block_cached__near_ridge'

def setup_inputs():

    _w = (lambda a: (lambda t: t.to(torch.bfloat16) if t.is_floating_point() else t)(torch.as_tensor(a)))
    def _A_setup():
        B, Sq, D = 32, 32, 640
        Hq, Hkv, Sk, Dh = 32, 32, 32, 128
        assert Hq % Hkv == 0, (Hq, Hkv)
        return {
            "x": _w((lambda *s: torch.randn(*s, dtype=torch.bfloat16) * 0.8)(B, Sq, D)),
            "k_cache": _w((lambda *s: torch.randn(*s, dtype=torch.bfloat16) * 0.8)(B, Hkv, Sk, Dh)),
            "v_cache": _w((lambda *s: torch.randn(*s, dtype=torch.bfloat16) * 0.05)(B, Hkv, Sk, Dh)),
            "wq": _w((lambda *s: torch.randn(*s, dtype=torch.bfloat16) * 0.8)(D, Hq * Dh) * (D ** -0.5)),
            "wo": _w((lambda *s: torch.randn(*s, dtype=torch.bfloat16) * 0.05)(Hq * Dh, D) * ((Hq * Dh) ** -0.5)),
        }
    _A_in = _A_setup()

    def _B_setup():
        B, Sq, D = 32, 32, 640
        Hq, Hkv, Sk, Dh = 32, 32, 32, 128
        assert Hq % Hkv == 0, (Hq, Hkv)
        return {
            "x": _w((lambda *s: torch.randn(*s, dtype=torch.bfloat16) * 0.8)(B, Sq, D)),
            "k_cache": _w((lambda *s: torch.randn(*s, dtype=torch.bfloat16) * 0.8)(B, Hkv, Sk, Dh)),
            "v_cache": _w((lambda *s: torch.randn(*s, dtype=torch.bfloat16) * 0.05)(B, Hkv, Sk, Dh)),
            "wq": _w((lambda *s: torch.randn(*s, dtype=torch.bfloat16) * 0.8)(D, Hq * Dh) * (D ** -0.5)),
            "wo": _w((lambda *s: torch.randn(*s, dtype=torch.bfloat16) * 0.05)(Hq * Dh, D) * ((Hq * Dh) ** -0.5)),
        }
    _B_in = _B_setup()

    return {
        "A_x": _A_in["x"],
        "A_k_cache": _A_in["k_cache"],
        "A_v_cache": _A_in["v_cache"],
        "A_wq": _A_in["wq"],
        "A_wo": _A_in["wo"],
        "B_x": _B_in["x"],
        "B_k_cache": _B_in["k_cache"],
        "B_v_cache": _B_in["v_cache"],
        "B_wq": _B_in["wq"],
        "B_wo": _B_in["wo"],
    }

def reference(A_x, A_k_cache, A_v_cache, A_wq, A_wo, B_x, B_k_cache, B_v_cache, B_wq, B_wo):
    def _A_ref(x, k_cache, v_cache, wq, wo):
        B, Sq, D = x.shape
        Hq, Dh = 32, 128
        Hkv = k_cache.shape[1]
        rep = Hq // Hkv
        q = (lambda x, *d: x.permute(*d))((x @ wq).reshape(B, Sq, Hq, Dh), 0, 2, 1, 3)
        k = (lambda x, n, axis: torch.repeat_interleave(x, n, dim=axis))(k_cache, rep, axis=1)
        v = (lambda x, n, axis: torch.repeat_interleave(x, n, dim=axis))(v_cache, rep, axis=1)
        scores = torch.einsum("bhqd,bhkd->bhqk", q, k) * (Dh ** -0.5)
        p = _softmax(scores, axis=-1)
        o = torch.einsum("bhqk,bhkd->bhqd", p, v)
        return (lambda x, *d: x.permute(*d))(o, 0, 2, 1, 3).reshape(B, Sq, Hq * Dh) @ wo

    def _B_ref(x, k_cache, v_cache, wq, wo):
        B, Sq, D = x.shape
        Hq, Dh = 32, 128
        Hkv = k_cache.shape[1]
        rep = Hq // Hkv
        q = (lambda x, *d: x.permute(*d))((x @ wq).reshape(B, Sq, Hq, Dh), 0, 2, 1, 3)
        k = (lambda x, n, axis: torch.repeat_interleave(x, n, dim=axis))(k_cache, rep, axis=1)
        v = (lambda x, n, axis: torch.repeat_interleave(x, n, dim=axis))(v_cache, rep, axis=1)
        scores = torch.einsum("bhqd,bhkd->bhqk", q, k) * (Dh ** -0.5)
        p = _softmax(scores, axis=-1)
        o = torch.einsum("bhqk,bhkd->bhqd", p, v)
        return (lambda x, *d: x.permute(*d))(o, 0, 2, 1, 3).reshape(B, Sq, Hq * Dh) @ wo

    a = _A_ref(A_x, A_k_cache, A_v_cache, A_wq, A_wo)
    b = _B_ref(B_x, B_k_cache, B_v_cache, B_wq, B_wo)
    return torch.concatenate([a, b], axis=-1)
```

```asm
; @launch grid=(256,1,1) block=(256,1,1) lds=163840
.amdgcn_target "amdgcn-amd-amdhsa--gfx950"
.text
.globl concat_heads__gqa_block_cached__gqa_block_cached__near_ridge_kernel
.p2align 8
.type concat_heads__gqa_block_cached__gqa_block_cached__near_ridge_kernel,@function
concat_heads__gqa_block_cached__gqa_block_cached__near_ridge_kernel:
    s_cmp_ge_u32 s2, 256
    s_cbranch_scc1 L_end
    s_load_dwordx16 s[40:55], s[0:1], 0
    s_load_dwordx8 s[56:63], s[0:1], 64
    s_load_dwordx2 s[64:65], s[0:1], 96
    s_getpc_b64 s[4:5]
L_pc0:
    s_and_b32 s3, s2, 0xf8
    s_lshl_b32 s3, s3, 1
    s_add_u32 s3, s3, L_table-L_pc0
    s_load_dwordx4 s[68:71], s[4:5], s3
    v_lshrrev_b32 v165, 6, v0
    v_and_b32 v164, 63, v0
    v_readfirstlane_b32 s72, v165
    s_bfe_u32 s73, s2, 0x10002
    s_and_b32 s74, s2, 3
    s_lshr_b32 s75, s2, 5
    s_bfe_u32 s76, s2, 0x20003
    s_lshr_b32 s77, s72, 1
    s_and_b32 s78, s72, 1
    v_lshrrev_b32 v160, 4, v164
    v_and_b32 v161, 15, v164
    s_lshl_b32 s79, s72, 12
    s_lshl_b32 s3, s72, 11
    s_add_u32 s80, s3, 16384
    s_and_b32 s3, s74, 1
    s_xor_b32 s3, s3, s78
    s_lshl_b32 s3, s3, 4
    s_lshl_b32 s4, s75, 7
    s_add_u32 s3, s3, s4
    s_lshl_b32 s4, s77, 6
    s_add_u32 s3, s3, s4
    v_lshrrev_b32 v165, 3, v164
    v_add_u32 v165, s3, v165
    v_mul_u32_u24 v165, 1280, v165
    v_and_b32 v166, 7, v164
    v_xor_b32 v166, v166, v160
    v_lshl_add_u32 v144, v166, 4, v165
    v_xor_b32 v145, 64, v144
    v_add_u32 v145, 9216, v145
    s_lshr_b32 s5, s74, 1
    s_mul_i32 s84, s5, 40960
    s_sub_u32 s85, 40960, s84
    s_lshl_b32 s3, s74, 2
    s_add_u32 s3, s3, s76
    s_lshl_b32 s3, s3, 9
    s_lshl_b32 s4, s72, 17
    s_add_u32 s3, s3, s4
    v_lshlrev_b32 v165, 13, v160
    v_add_u32 v165, s3, v165
    v_and_b32 v166, 1, v161
    v_lshl_add_u32 v165, v166, 4, v165
    v_lshrrev_b32 v166, 1, v161
    v_xor_b32 v166, v166, v160
    v_lshrrev_b32 v167, 2, v166
    v_lshl_add_u32 v140, v167, 8, v165
    v_and_b32 v167, 3, v166
    v_lshl_add_u32 v140, v167, 5, v140
    v_add_u32 v141, 31744, v140
    v_xor_b32 v142, 0x100, v140
    v_add_u32 v142, 63488, v142
    v_add_u32 v143, 31744, v142
    s_mov_b32 s10, 1310720
    s_mov_b32 s11, 0x20000
    s_mov_b32 s22, 5242880
    s_mov_b32 s23, 0x20000
    s_cmp_eq_u32 s73, 0
    s_waitcnt lgkmcnt(0)
    s_cselect_b64 s[8:9], s[40:41], s[50:51]
    s_cselect_b64 s[20:21], s[46:47], s[56:57]
    s_cselect_b64 s[12:13], s[42:43], s[52:53]
    s_cselect_b64 s[16:17], s[44:45], s[54:55]
    s_cselect_b64 s[24:25], s[48:49], s[58:59]
    s_bfe_u32 s66, s68, 0x40000
    s_lshl_b32 s66, s66, 7
    s_add_u32 s89, s84, s66
    s_add_u32 m0, s80, 73728
    s_nop 0
    buffer_load_dwordx4 v144, s[8:11], s89 offen offset:0 lds
    buffer_load_dwordx4 v145, s[8:11], s89 offen offset:1024 lds
    s_bfe_u32 s88, s68, 0x40000
    s_lshl_b32 s88, s88, 19
    s_add_u32 m0, s79, 98304
    s_nop 0
    buffer_load_dwordx4 v140, s[20:23], s88 offen offset:0 lds
    buffer_load_dwordx4 v141, s[20:23], s88 offen offset:1024 lds
    buffer_load_dwordx4 v142, s[20:23], s88 offen offset:2048 lds
    buffer_load_dwordx4 v143, s[20:23], s88 offen offset:3072 lds
    s_add_u32 s89, s85, s66
    s_add_u32 m0, s80, 98304
    s_nop 0
    buffer_load_dwordx4 v144, s[8:11], s89 offen offset:0 lds
    buffer_load_dwordx4 v145, s[8:11], s89 offen offset:1024 lds
    s_mov_b64 s[32:33], s[62:63]
    s_mov_b32 s34, 256
    s_mov_b32 s35, 0x20000
    s_lshl_b32 s3, s73, 3
    s_add_u32 s3, s3, s75
    s_lshl_b32 s98, s3, 4
    v_mov_b32 v255, 0
    s_and_b32 s3, s2, 0x1b
    s_or_b32 s3, s3, s72
    s_cbranch_scc1 L_nolead
    s_memrealtime s[4:5]
    s_waitcnt lgkmcnt(0)
    s_mul_i32 s5, s5, 0x7f4a7c15
    s_mul_hi_u32 s6, s4, 0x7f4a7c15
    s_add_u32 s5, s5, s6
    s_mul_i32 s6, s4, 0x9e3779b9
    s_add_u32 s5, s5, s6
    s_mul_i32 s4, s4, 0x7f4a7c15
    v_mov_b32 v230, s4
    v_mov_b32 v231, s5
    s_mov_b64 exec, 1
    buffer_store_dwordx2 v[230:231], v255, s[32:35], s98 offen sc1
    s_mov_b64 exec, -1
L_nolead:
    v_bfe_u32 v162, v164, 2, 2
    v_and_b32 v163, 3, v164
    v_and_b32 v165, 1, v160
    v_lshl_or_b32 v165, v165, 2, v162
    s_lshl_b32 s3, s78, 2
    v_xor_b32 v165, s3, v165
    v_lshl_add_u32 v166, v160, 3, v162
    v_lshlrev_b32 v167, 8, v166
    v_lshl_add_u32 v167, v163, 3, v167
    v_lshl_add_u32 v128, v165, 5, v167
    v_xor_b32 v129, 32, v128
    v_xor_b32 v130, 64, v128
    v_xor_b32 v131, 96, v128
    v_add_u32 v132, 73728, v128
    v_add_u32 v133, 73728, v129
    v_add_u32 v134, 73728, v130
    v_add_u32 v135, 73728, v131
    v_lshrrev_b32 v165, 1, v161
    v_xor_b32 v165, v165, v160
    v_lshlrev_b32 v165, 4, v165
    v_lshl_add_u32 v165, v161, 7, v165
    s_lshl_b32 s3, s77, 12
    s_add_u32 s3, s3, 16384
    v_add_u32 v136, s3, v165
    v_xor_b32 v137, 64, v136
    s_lshl_b32 s3, s77, 13
    v_add_u32 v243, s3, v165
    v_add_u32 v138, 73728, v136
    v_add_u32 v139, 73728, v137
    s_mov_b32 s14, 8388608
    s_mov_b32 s15, 0x20000
    s_lshl_b32 s3, s78, 1
    s_add_u32 s3, s3, s77
    s_lshl_b32 s3, s3, 12
    s_add_u32 s82, s3, 147456
    s_lshl_b32 s3, s75, 1
    s_add_u32 s3, s3, s77
    s_lshl_b32 s3, s3, 19
    s_lshl_b32 s4, s74, 2
    s_add_u32 s4, s4, s76
    s_lshl_b32 s4, s4, 1
    s_add_u32 s4, s4, s78
    s_lshl_b32 s4, s4, 13
    s_add_u32 s3, s3, s4
    s_lshr_b32 s5, s74, 1
    s_lshl_b32 s5, s5, 18
    s_add_u32 s86, s3, s5
    s_xor_b32 s87, s86, 0x40000
    v_xor_b32 v166, v161, v160
    v_lshlrev_b32 v166, 4, v166
    v_lshl_add_u32 v146, v160, 8, v166
    v_xor_b32 v147, 64, v146
    v_xor_b32 v148, 128, v146
    v_xor_b32 v149, 192, v146
    s_getpc_b64 s[4:5]
L_pc:
    s_sub_u32 s4, s4, L_pc-concat_heads__gqa_block_cached__gqa_block_cached__near_ridge_kernel
    s_subb_u32 s5, s5, 0
    s_lshr_b32 s3, s2, 3
    s_and_b32 s3, s3, 7
    s_lshl_b32 s3, s3, 2
    s_add_u32 s3, s3, s72
    s_lshl_b32 s3, s3, 11
    v_lshl_add_u32 v165, v161, 7, s3
    v_min_u32 v165, L_last-concat_heads__gqa_block_cached__gqa_block_cached__near_ridge_kernel, v165
    global_load_dword v168, v165, s[4:5]
    s_add_u32 s88, s88, 128
    s_add_u32 m0, s79, 122880
    s_nop 0
    buffer_load_dwordx4 v140, s[20:23], s88 offen offset:0 lds
    buffer_load_dwordx4 v141, s[20:23], s88 offen offset:1024 lds
    buffer_load_dwordx4 v142, s[20:23], s88 offen offset:2048 lds
    buffer_load_dwordx4 v143, s[20:23], s88 offen offset:3072 lds
    s_bfe_u32 s66, s68, 0x40004
    s_lshl_b32 s66, s66, 7
    s_add_u32 s89, s84, s66
    s_add_u32 m0, s80, 122880
    s_nop 0
    buffer_load_dwordx4 v144, s[8:11], s89 offen offset:0 lds
    buffer_load_dwordx4 v145, s[8:11], s89 offen offset:1024 lds
    s_bfe_u32 s88, s68, 0x40004
    s_lshl_b32 s88, s88, 19
    s_add_u32 m0, s79, 0
    s_nop 0
    buffer_load_dwordx4 v140, s[20:23], s88 offen offset:0 lds
    buffer_load_dwordx4 v141, s[20:23], s88 offen offset:1024 lds
    buffer_load_dwordx4 v142, s[20:23], s88 offen offset:2048 lds
    buffer_load_dwordx4 v143, s[20:23], s88 offen offset:3072 lds
    s_add_u32 s89, s85, s66
    s_add_u32 m0, s80, 0
    s_nop 0
    buffer_load_dwordx4 v144, s[8:11], s89 offen offset:0 lds
    buffer_load_dwordx4 v145, s[8:11], s89 offen offset:1024 lds
    s_mov_b64 exec, 0
    s_cmp_eq_u32 s72, 1
    s_cbranch_scc1 L_pad1
    s_cmp_eq_u32 s72, 2
    s_cbranch_scc1 L_pad2
    s_cmp_eq_u32 s72, 3
    s_cbranch_scc1 L_pad3
    s_branch L_main
.p2align 4
L_table:
.long 0x65742130, 0x98, 0x76543210, 0
.long 0x68532410, 0x97, 0x10765432, 1
.long 0x96435021, 0x87, 0x32107654, 2
.long 0x75463102, 0x98, 0x54321076, 3
.long 0x75463102, 0x98, 0x27654310, 3
.long 0x65742130, 0x98, 0x41076532, 0
.long 0x68532410, 0x97, 0x63210754, 1
.long 0x96435021, 0x87, 0x5432176, 2
.long 0x96435021, 0x87, 0x32765410, 2
.long 0x75463102, 0x98, 0x54107632, 3
.long 0x65742130, 0x98, 0x76321054, 0
.long 0x68532410, 0x97, 0x10543276, 1
.long 0x68532410, 0x97, 0x43276510, 1
.long 0x96435021, 0x87, 0x65410732, 2
.long 0x75463102, 0x98, 0x7632154, 3
.long 0x65742130, 0x98, 0x21054376, 0
.long 0x65742130, 0x98, 0x54327610, 0
.long 0x68532410, 0x97, 0x76541032, 1
.long 0x96435021, 0x87, 0x10763254, 2
.long 0x75463102, 0x98, 0x32105476, 3
.long 0x75463102, 0x98, 0x65432710, 3
.long 0x65742130, 0x98, 0x7654132, 0
.long 0x68532410, 0x97, 0x21076354, 1
.long 0x96435021, 0x87, 0x43210576, 2
.long 0x96435021, 0x87, 0x27654310, 2
.long 0x75463102, 0x98, 0x41076532, 3
.long 0x65742130, 0x98, 0x63210754, 0
.long 0x68532410, 0x97, 0x5432176, 1
.long 0x68532410, 0x97, 0x54327610, 1
.long 0x96435021, 0x87, 0x76541032, 2
.long 0x75463102, 0x98, 0x10763254, 3
.long 0x65742130, 0x98, 0x32105476, 0
.p2align 12
L_main:
    s_mov_b64 exec, -1
    s_waitcnt vmcnt(13)
    s_barrier
    ds_read_b128 a[64:67], v138 offset:0
    ds_read_b128 a[68:71], v139 offset:0
    ds_read_b128 a[72:75], v138 offset:2048
    ds_read_b128 a[76:79], v139 offset:2048
    ds_read_b64_tr_b16 a[0:1], v132 offset:24576
    ds_read_b64_tr_b16 a[2:3], v132 offset:25600
    ds_read_b64_tr_b16 a[4:5], v132 offset:32768
    ds_read_b64_tr_b16 a[6:7], v132 offset:33792
    ds_read_b64_tr_b16 a[8:9], v133 offset:24576
    ds_read_b64_tr_b16 a[10:11], v133 offset:25600
    ds_read_b64_tr_b16 a[12:13], v133 offset:32768
    ds_read_b64_tr_b16 a[14:15], v133 offset:33792
    ds_read_b64_tr_b16 a[16:17], v134 offset:24576
    ds_read_b64_tr_b16 a[18:19], v134 offset:25600
    ds_read_b64_tr_b16 a[20:21], v134 offset:32768
    ds_read_b64_tr_b16 a[22:23], v134 offset:33792
    ds_read_b64_tr_b16 a[24:25], v135 offset:24576
    ds_read_b64_tr_b16 a[26:27], v135 offset:25600
    ds_read_b64_tr_b16 a[28:29], v135 offset:32768
    ds_read_b64_tr_b16 a[30:31], v135 offset:33792
    ds_read_b128 a[80:83], v138 offset:24576
    ds_read_b128 a[84:87], v139 offset:24576
    ds_read_b128 a[88:91], v138 offset:26624
    ds_read_b128 a[92:95], v139 offset:26624
    s_add_u32 s88, s88, 128
    s_add_u32 m0, s79, 24576
    s_nop 0
    buffer_load_dwordx4 v140, s[20:23], s88 offen offset:0 lds
    buffer_load_dwordx4 v141, s[20:23], s88 offen offset:1024 lds
    buffer_load_dwordx4 v142, s[20:23], s88 offen offset:2048 lds
    buffer_load_dwordx4 v143, s[20:23], s88 offen offset:3072 lds
    s_bfe_u32 s66, s68, 0x40008
    s_lshl_b32 s66, s66, 7
    s_add_u32 s89, s84, s66
    s_add_u32 m0, s80, 24576
    s_nop 0
    buffer_load_dwordx4 v144, s[8:11], s89 offen offset:0 lds
    buffer_load_dwordx4 v145, s[8:11], s89 offen offset:1024 lds
    s_bfe_u32 s88, s68, 0x40008
    s_lshl_b32 s88, s88, 19
    s_add_u32 m0, s79, 49152
    s_nop 0
    buffer_load_dwordx4 v140, s[20:23], s88 offen offset:0 lds
    buffer_load_dwordx4 v141, s[20:23], s88 offen offset:1024 lds
    buffer_load_dwordx4 v142, s[20:23], s88 offen offset:2048 lds
    buffer_load_dwordx4 v143, s[20:23], s88 offen offset:3072 lds
    s_add_u32 s89, s85, s66
    s_add_u32 m0, s80, 49152
    s_nop 0
    buffer_load_dwordx4 v144, s[8:11], s89 offen offset:0 lds
    buffer_load_dwordx4 v145, s[8:11], s89 offen offset:1024 lds
    s_waitcnt vmcnt(18) lgkmcnt(0)
    s_barrier
    v_mfma_f32_16x16x32_bf16 v[64:67], a[0:3], a[64:67], 0
    ds_read_b64_tr_b16 a[32:33], v132 offset:49152
    v_lshlrev_b32 v232, 4, v164
    v_mfma_f32_16x16x32_bf16 v[64:67], a[4:7], a[68:71], v[64:67]
    ds_read_b64_tr_b16 a[34:35], v132 offset:50176
    s_add_u32 s88, s88, 128
    v_mfma_f32_16x16x32_bf16 v[68:71], a[0:3], a[72:75], 0
    ds_read_b64_tr_b16 a[36:37], v132 offset:57344
    s_add_u32 m0, s79, 73728
    v_mfma_f32_16x16x32_bf16 v[68:71], a[4:7], a[76:79], v[68:71]
    buffer_load_dwordx4 v140, s[20:23], s88 offen offset:0 lds
    v_mfma_f32_16x16x32_bf16 v[72:75], a[0:3], a[80:83], 0
    ds_read_b64_tr_b16 a[38:39], v132 offset:58368
    s_mov_b64 s[36:37], s[64:65]
    v_mfma_f32_16x16x32_bf16 v[72:75], a[4:7], a[84:87], v[72:75]
    ds_read_b64_tr_b16 a[40:41], v133 offset:49152
    s_mov_b32 s38, 268435456
    v_mfma_f32_16x16x32_bf16 v[76:79], a[0:3], a[88:91], 0
    ds_read_b64_tr_b16 a[42:43], v133 offset:50176
    s_mov_b32 s39, 0x20000
    v_mfma_f32_16x16x32_bf16 v[76:79], a[4:7], a[92:95], v[76:79]
    buffer_load_dwordx4 v141, s[20:23], s88 offen offset:1024 lds
    v_mfma_f32_16x16x32_bf16 v[0:3], a[8:11], a[64:67], 0
    ds_read_b64_tr_b16 a[44:45], v133 offset:57344
    s_mov_b64 s[28:29], s[60:61]
    v_mfma_f32_16x16x32_bf16 v[0:3], a[12:15], a[68:71], v[0:3]
    ds_read_b64_tr_b16 a[46:47], v133 offset:58368
    s_mov_b32 s30, 2621440
    v_mfma_f32_16x16x32_bf16 v[4:7], a[8:11], a[72:75], 0
    ds_read_b64_tr_b16 a[48:49], v134 offset:49152
    s_mov_b32 s31, 0x20000
    v_mfma_f32_16x16x32_bf16 v[4:7], a[12:15], a[76:79], v[4:7]
    ds_read_b64_tr_b16 a[50:51], v134 offset:50176
    s_and_b32 s3, s2, 7
    v_mfma_f32_16x16x32_bf16 v[8:11], a[8:11], a[80:83], 0
    buffer_load_dwordx4 v142, s[20:23], s88 offen offset:2048 lds
    v_mfma_f32_16x16x32_bf16 v[8:11], a[12:15], a[84:87], v[8:11]
    ds_read_b64_tr_b16 a[52:53], v134 offset:57344
    s_lshl_b32 s3, s3, 3
    v_mfma_f32_16x16x32_bf16 v[12:15], a[8:11], a[88:91], 0
    ds_read_b64_tr_b16 a[54:55], v134 offset:58368
    s_add_u32 s3, s3, s75
    v_mfma_f32_16x16x32_bf16 v[12:15], a[12:15], a[92:95], v[12:15]
    ds_read_b64_tr_b16 a[56:57], v135 offset:49152
    s_lshl_b32 s3, s3, 16
    v_mfma_f32_16x16x32_bf16 v[80:83], a[16:19], a[64:67], 0
    buffer_load_dwordx4 v143, s[20:23], s88 offen offset:3072 lds
    s_bfe_u32 s66, s68, 0x4000c
    v_mfma_f32_16x16x32_bf16 v[80:83], a[20:23], a[68:71], v[80:83]
    ds_read_b64_tr_b16 a[58:59], v135 offset:50176
    s_lshl_b32 s66, s66, 7
    v_mfma_f32_16x16x32_bf16 v[84:87], a[16:19], a[72:75], 0
    ds_read_b64_tr_b16 a[60:61], v135 offset:57344
    s_add_u32 s89, s84, s66
    v_mfma_f32_16x16x32_bf16 v[84:87], a[20:23], a[76:79], v[84:87]
    ds_read_b64_tr_b16 a[62:63], v135 offset:58368
    s_add_u32 m0, s80, 73728
    v_mfma_f32_16x16x32_bf16 v[88:91], a[16:19], a[80:83], 0
    buffer_load_dwordx4 v144, s[8:11], s89 offen offset:0 lds
    v_mfma_f32_16x16x32_bf16 v[88:91], a[20:23], a[84:87], v[88:91]
    ds_read_b128 a[96:99], v138 offset:49152
    s_add_u32 s3, s3, 0
    v_mfma_f32_16x16x32_bf16 v[92:95], a[16:19], a[88:91], 0
    ds_read_b128 a[100:103], v139 offset:49152
    s_lshl_b32 s4, s72, 11
    v_mfma_f32_16x16x32_bf16 v[92:95], a[20:23], a[92:95], v[92:95]
    ds_read_b128 a[104:107], v138 offset:51200
    s_add_u32 s92, s3, s4
    v_mfma_f32_16x16x32_bf16 v[16:19], a[24:27], a[64:67], 0
    ds_read_b128 a[108:111], v139 offset:51200
    s_add_u32 s83, s4, 147456
    v_mfma_f32_16x16x32_bf16 v[16:19], a[28:31], a[68:71], v[16:19]
    buffer_load_dwordx4 v145, s[8:11], s89 offen offset:1024 lds
    v_mfma_f32_16x16x32_bf16 v[20:23], a[24:27], a[72:75], 0
    s_bfe_u32 s88, s68, 0x4000c
    s_lshl_b32 s4, s76, 1
    v_mfma_f32_16x16x32_bf16 v[20:23], a[28:31], a[76:79], v[20:23]
    s_lshl_b32 s88, s88, 19
    s_add_u32 s4, s4, s78
    v_mfma_f32_16x16x32_bf16 v[24:27], a[24:27], a[80:83], 0
    s_add_u32 m0, s79, 98304
    s_lshl_b32 s4, s4, 1
    v_mfma_f32_16x16x32_bf16 v[24:27], a[28:31], a[84:87], v[24:27]
    buffer_load_dwordx4 v140, s[20:23], s88 offen offset:0 lds
    v_mfma_f32_16x16x32_bf16 v[28:31], a[24:27], a[88:91], 0
    s_add_u32 s4, s4, s77
    s_lshl_b32 s4, s4, 12
    v_mfma_f32_16x16x32_bf16 v[28:31], a[28:31], a[92:95], v[28:31]
    s_add_u32 s91, s3, s4
    v_lshrrev_b32 v165, 1, v160
    s_waitcnt vmcnt(19) lgkmcnt(0)
    s_barrier
    v_mfma_f32_16x16x32_bf16 v[96:99], a[32:35], a[64:67], 0
    ds_read_b64_tr_b16 a[0:1], v128 offset:0
    s_add_u32 s90, s86, 0
    v_mfma_f32_16x16x32_bf16 v[96:99], a[36:39], a[68:71], v[96:99]
    ds_read_b64_tr_b16 a[2:3], v128 offset:1024
    s_mov_b32 m0, s82
    v_mfma_f32_16x16x32_bf16 v[100:103], a[32:35], a[72:75], 0
    buffer_load_dwordx4 v146, s[12:15], s90 offen offset:0 lds
    v_mfma_f32_16x16x32_bf16 v[100:103], a[36:39], a[76:79], v[100:103]
    ds_read_b64_tr_b16 a[4:5], v128 offset:8192
    v_xor_b32 v165, v165, v161
    v_mfma_f32_16x16x32_bf16 v[104:107], a[32:35], a[80:83], 0
    ds_read_b64_tr_b16 a[6:7], v128 offset:9216
    v_lshlrev_b32 v165, 4, v165
    v_mfma_f32_16x16x32_bf16 v[104:107], a[36:39], a[84:87], v[104:107]
    buffer_load_dwordx4 v147, s[12:15], s90 offen offset:1024 lds
    v_mfma_f32_16x16x32_bf16 v[108:111], a[32:35], a[88:91], 0
    ds_read_b64_tr_b16 a[8:9], v129 offset:0
    ds_read_b64_tr_b16 a[10:11], v129 offset:1024
    v_lshl_add_u32 v165, v161, 8, v165
    v_mfma_f32_16x16x32_bf16 v[108:111], a[36:39], a[92:95], v[108:111]
    ds_read_b64_tr_b16 a[12:13], v129 offset:8192
    v_and_b32 v166, 1, v160
    v_mfma_f32_16x16x32_bf16 v[32:35], a[40:43], a[64:67], 0
    buffer_load_dwordx4 v148, s[12:15], s90 offen offset:2048 lds
    v_mfma_f32_16x16x32_bf16 v[32:35], a[44:47], a[68:71], v[32:35]
    ds_read_b64_tr_b16 a[14:15], v129 offset:9216
    v_lshl_add_u32 v165, v166, 3, v165
    v_mfma_f32_16x16x32_bf16 v[36:39], a[40:43], a[72:75], 0
    buffer_load_dwordx4 v149, s[12:15], s90 offen offset:3072 lds
    v_mfma_f32_16x16x32_bf16 v[36:39], a[44:47], a[76:79], v[36:39]
    ds_read_b64_tr_b16 a[16:17], v130 offset:0
    v_add_u32 v150, s82, v165
    v_mfma_f32_16x16x32_bf16 v[40:43], a[40:43], a[80:83], 0
    ds_read_b64_tr_b16 a[18:19], v130 offset:1024
    s_add_u32 m0, s79, 98304
    v_mfma_f32_16x16x32_bf16 v[40:43], a[44:47], a[84:87], v[40:43]
    buffer_load_dwordx4 v141, s[20:23], s88 offen offset:1024 lds
    v_mfma_f32_16x16x32_bf16 v[44:47], a[40:43], a[88:91], 0
    ds_read_b64_tr_b16 a[20:21], v130 offset:8192
    v_xor_b32 v151, 32, v150
    v_mfma_f32_16x16x32_bf16 v[44:47], a[44:47], a[92:95], v[44:47]
    ds_read_b64_tr_b16 a[22:23], v130 offset:9216
    v_xor_b32 v152, 64, v150
    v_mfma_f32_16x16x32_bf16 v[112:115], a[48:51], a[64:67], 0
    buffer_load_dwordx4 v142, s[20:23], s88 offen offset:2048 lds
    v_mfma_f32_16x16x32_bf16 v[112:115], a[52:55], a[68:71], v[112:115]
    ds_read_b64_tr_b16 a[24:25], v131 offset:0
    v_xor_b32 v153, 96, v150
    v_mfma_f32_16x16x32_bf16 v[116:119], a[48:51], a[72:75], 0
    ds_read_b64_tr_b16 a[26:27], v131 offset:1024
    v_xor_b32 v154, 128, v150
    v_mfma_f32_16x16x32_bf16 v[116:119], a[52:55], a[76:79], v[116:119]
    buffer_load_dwordx4 v143, s[20:23], s88 offen offset:3072 lds
    v_mfma_f32_16x16x32_bf16 v[120:123], a[48:51], a[80:83], 0
    ds_read_b64_tr_b16 a[28:29], v131 offset:8192
    ds_read_b64_tr_b16 a[30:31], v131 offset:9216
    s_add_u32 s89, s85, s66
    v_mfma_f32_16x16x32_bf16 v[120:123], a[52:55], a[84:87], v[120:123]
    ds_read_b128 a[112:115], v136 offset:0
    s_add_u32 m0, s80, 98304
    v_mfma_f32_16x16x32_bf16 v[124:127], a[48:51], a[88:91], 0
    buffer_load_dwordx4 v144, s[8:11], s89 offen offset:0 lds
    v_mfma_f32_16x16x32_bf16 v[124:127], a[52:55], a[92:95], v[124:127]
    ds_read_b128 a[116:119], v137 offset:0
    v_xor_b32 v155, 160, v150
    v_mfma_f32_16x16x32_bf16 v[48:51], a[56:59], a[64:67], 0
    buffer_load_dwordx4 v145, s[8:11], s89 offen offset:1024 lds
    v_mfma_f32_16x16x32_bf16 v[48:51], a[60:63], a[68:71], v[48:51]
    ds_read_b128 a[120:123], v136 offset:2048
    s_add_u32 s88, s88, 128
    v_mfma_f32_16x16x32_bf16 v[52:55], a[56:59], a[72:75], 0
    ds_read_b128 a[124:127], v137 offset:2048
    s_add_u32 m0, s79, 122880
    v_mfma_f32_16x16x32_bf16 v[52:55], a[60:63], a[76:79], v[52:55]
    buffer_load_dwordx4 v140, s[20:23], s88 offen offset:0 lds
    v_mfma_f32_16x16x32_bf16 v[56:59], a[56:59], a[80:83], 0
    v_xor_b32 v156, 192, v150
    v_xor_b32 v157, 224, v150
    v_mfma_f32_16x16x32_bf16 v[56:59], a[60:63], a[84:87], v[56:59]
    s_lshl_b32 s3, s73, 3
    s_add_u32 s3, s3, s75
    v_mfma_f32_16x16x32_bf16 v[60:63], a[56:59], a[88:91], 0
    buffer_load_dwordx4 v141, s[20:23], s88 offen offset:1024 lds
    v_mfma_f32_16x16x32_bf16 v[60:63], a[60:63], a[92:95], v[60:63]
    s_lshl_b32 s3, s3, 2
    s_add_u32 s3, s3, s76
    s_waitcnt vmcnt(24) lgkmcnt(0)
    s_barrier
    s_mov_b64 exec, 0
    s_cmp_eq_u32 s72, 0
    s_cbranch_scc1 L_pad4
    s_cmp_eq_u32 s72, 1
    s_cbranch_scc1 L_pad5
    s_cmp_eq_u32 s72, 2
    s_cbranch_scc1 L_pad6
    s_cmp_eq_u32 s72, 3
    s_cbranch_scc1 L_pad7
L_hop2:
    s_mov_b64 exec, -1
    v_mfma_f32_16x16x32_bf16 v[64:67], a[0:3], a[96:99], v[64:67]
    ds_read_b64_tr_b16 a[32:33], v128 offset:24576
    s_lshl_b32 s3, s3, 2
    v_mfma_f32_16x16x32_bf16 v[64:67], a[4:7], a[100:103], v[64:67]
    ds_read_b64_tr_b16 a[34:35], v128 offset:25600
    s_mul_i32 s4, s72, 3072
    v_mfma_f32_16x16x32_bf16 v[68:71], a[0:3], a[104:107], v[68:71]
    ds_read_b64_tr_b16 a[36:37], v128 offset:32768
    s_add_u32 s4, s4, 4194304
    v_mfma_f32_16x16x32_bf16 v[68:71], a[4:7], a[108:111], v[68:71]
    buffer_load_dwordx4 v142, s[20:23], s88 offen offset:2048 lds
    v_mfma_f32_16x16x32_bf16 v[72:75], a[0:3], a[112:115], v[72:75]
    ds_read_b64_tr_b16 a[38:39], v128 offset:33792
    s_add_u32 s5, s3, s74
    v_mfma_f32_16x16x32_bf16 v[72:75], a[4:7], a[116:119], v[72:75]
    ds_read_b64_tr_b16 a[40:41], v129 offset:24576
    s_mul_i32 s5, s5, 36864
    v_mfma_f32_16x16x32_bf16 v[76:79], a[0:3], a[120:123], v[76:79]
    ds_read_b64_tr_b16 a[42:43], v129 offset:25600
    s_add_u32 s96, s5, s4
    v_mfma_f32_16x16x32_bf16 v[76:79], a[4:7], a[124:127], v[76:79]
    buffer_load_dwordx4 v143, s[20:23], s88 offen offset:3072 lds
    v_mfma_f32_16x16x32_bf16 v[0:3], a[8:11], a[96:99], v[0:3]
    ds_read_b64_tr_b16 a[44:45], v129 offset:32768
    s_bfe_u32 s66, s68, 0x40010
    v_mfma_f32_16x16x32_bf16 v[0:3], a[12:15], a[100:103], v[0:3]
    ds_read_b64_tr_b16 a[46:47], v129 offset:33792
    s_lshl_b32 s66, s66, 7
    v_mfma_f32_16x16x32_bf16 v[4:7], a[8:11], a[104:107], v[4:7]
    ds_read_b64_tr_b16 a[48:49], v130 offset:24576
    s_add_u32 s89, s84, s66
    v_mfma_f32_16x16x32_bf16 v[4:7], a[12:15], a[108:111], v[4:7]
    ds_read_b64_tr_b16 a[50:51], v130 offset:25600
    s_add_u32 m0, s80, 122880
    v_mfma_f32_16x16x32_bf16 v[8:11], a[8:11], a[112:115], v[8:11]
    buffer_load_dwordx4 v144, s[8:11], s89 offen offset:0 lds
    v_mfma_f32_16x16x32_bf16 v[8:11], a[12:15], a[116:119], v[8:11]
    ds_read_b64_tr_b16 a[52:53], v130 offset:32768
    s_xor_b32 s5, s74, 1
    v_mfma_f32_16x16x32_bf16 v[12:15], a[8:11], a[120:123], v[12:15]
    ds_read_b64_tr_b16 a[54:55], v130 offset:33792
    s_add_u32 s5, s5, s3
    v_mfma_f32_16x16x32_bf16 v[12:15], a[12:15], a[124:127], v[12:15]
    ds_read_b64_tr_b16 a[56:57], v131 offset:24576
    s_mul_i32 s5, s5, 36864
    v_mfma_f32_16x16x32_bf16 v[80:83], a[16:19], a[96:99], v[80:83]
    buffer_load_dwordx4 v145, s[8:11], s89 offen offset:1024 lds
    v_mfma_f32_16x16x32_bf16 v[80:83], a[20:23], a[100:103], v[80:83]
    ds_read_b64_tr_b16 a[58:59], v131 offset:25600
    s_bfe_u32 s88, s68, 0x40010
    v_mfma_f32_16x16x32_bf16 v[84:87], a[16:19], a[104:107], v[84:87]
    ds_read_b64_tr_b16 a[60:61], v131 offset:32768
    s_lshl_b32 s88, s88, 19
    v_mfma_f32_16x16x32_bf16 v[84:87], a[20:23], a[108:111], v[84:87]
    ds_read_b64_tr_b16 a[62:63], v131 offset:33792
    s_add_u32 m0, s79, 0
    v_mfma_f32_16x16x32_bf16 v[88:91], a[16:19], a[112:115], v[88:91]
    buffer_load_dwordx4 v140, s[20:23], s88 offen offset:0 lds
    v_mfma_f32_16x16x32_bf16 v[88:91], a[20:23], a[116:119], v[88:91]
    ds_read_b128 a[64:67], v136 offset:24576
    s_add_u32 s5, s5, s4
    v_mfma_f32_16x16x32_bf16 v[92:95], a[16:19], a[120:123], v[92:95]
    ds_read_b128 a[68:71], v137 offset:24576
    s_add_u32 s93, s5, 0
    v_mfma_f32_16x16x32_bf16 v[92:95], a[20:23], a[124:127], v[92:95]
    ds_read_b128 a[72:75], v136 offset:26624
    s_xor_b32 s5, s74, 2
    v_mfma_f32_16x16x32_bf16 v[16:19], a[24:27], a[96:99], v[16:19]
    ds_read_b128 a[76:79], v137 offset:26624
    s_add_u32 s5, s5, s3
    v_mfma_f32_16x16x32_bf16 v[16:19], a[28:31], a[100:103], v[16:19]
    buffer_load_dwordx4 v141, s[20:23], s88 offen offset:1024 lds
    v_mfma_f32_16x16x32_bf16 v[20:23], a[24:27], a[104:107], v[20:23]
    s_mul_i32 s5, s5, 36864
    s_add_u32 s5, s5, s4
    v_mfma_f32_16x16x32_bf16 v[20:23], a[28:31], a[108:111], v[20:23]
    s_add_u32 s94, s5, 12288
    s_xor_b32 s5, s74, 3
    v_mfma_f32_16x16x32_bf16 v[24:27], a[24:27], a[112:115], v[24:27]
    s_add_u32 s5, s5, s3
    s_mul_i32 s5, s5, 36864
    v_mfma_f32_16x16x32_bf16 v[24:27], a[28:31], a[116:119], v[24:27]
    buffer_load_dwordx4 v142, s[20:23], s88 offen offset:2048 lds
    v_mfma_f32_16x16x32_bf16 v[28:31], a[24:27], a[120:123], v[28:31]
    s_add_u32 s5, s5, s4
    s_add_u32 s95, s5, 24576
    v_mfma_f32_16x16x32_bf16 v[28:31], a[28:31], a[124:127], v[28:31]
    s_mov_b32 s18, 8388608
    s_mov_b32 s19, 0x20000
    s_waitcnt vmcnt(25) lgkmcnt(0)
    s_barrier
    v_mfma_f32_16x16x32_bf16 v[96:99], a[32:35], a[96:99], v[96:99]
    ds_read_b64_tr_b16 a[0:1], v128 offset:49152
    s_mov_b32 s26, 5242880
    v_mfma_f32_16x16x32_bf16 v[96:99], a[36:39], a[100:103], v[96:99]
    ds_read_b64_tr_b16 a[2:3], v128 offset:50176
    s_mov_b32 s27, 0x20000
    v_mfma_f32_16x16x32_bf16 v[100:103], a[32:35], a[104:107], v[100:103]
    ds_read_b64_tr_b16 a[4:5], v128 offset:57344
    s_mul_i32 s3, s72, 5120
    v_mfma_f32_16x16x32_bf16 v[100:103], a[36:39], a[108:111], v[100:103]
    buffer_load_dwordx4 v143, s[20:23], s88 offen offset:3072 lds
    v_mfma_f32_16x16x32_bf16 v[104:107], a[32:35], a[112:115], v[104:107]
    ds_read_b64_tr_b16 a[6:7], v128 offset:58368
    s_add_u32 s81, s3, 16384
    v_mfma_f32_16x16x32_bf16 v[104:107], a[36:39], a[116:119], v[104:107]
    ds_read_b64_tr_b16 a[8:9], v129 offset:49152
    s_add_u32 s89, s85, s66
    v_mfma_f32_16x16x32_bf16 v[108:111], a[32:35], a[120:123], v[108:111]
    ds_read_b64_tr_b16 a[10:11], v129 offset:50176
    s_add_u32 m0, s80, 0
    v_mfma_f32_16x16x32_bf16 v[108:111], a[36:39], a[124:127], v[108:111]
    buffer_load_dwordx4 v144, s[8:11], s89 offen offset:0 lds
    v_mfma_f32_16x16x32_bf16 v[32:35], a[40:43], a[96:99], v[32:35]
    ds_read_b64_tr_b16 a[12:13], v129 offset:57344
    v_lshl_add_u32 v166, v160, 3, v162
    v_mfma_f32_16x16x32_bf16 v[32:35], a[44:47], a[100:103], v[32:35]
    ds_read_b64_tr_b16 a[14:15], v129 offset:58368
    v_mul_u32_u24 v167, 320, v166
    v_mfma_f32_16x16x32_bf16 v[36:39], a[40:43], a[104:107], v[36:39]
    ds_read_b64_tr_b16 a[16:17], v130 offset:49152
    v_lshl_add_u32 v167, v163, 3, v167
    v_mfma_f32_16x16x32_bf16 v[36:39], a[44:47], a[108:111], v[36:39]
    ds_read_b64_tr_b16 a[18:19], v130 offset:50176
    v_add_u32 v167, 16384, v167
    v_mfma_f32_16x16x32_bf16 v[40:43], a[40:43], a[112:115], v[40:43]
    buffer_load_dwordx4 v145, s[8:11], s89 offen offset:1024 lds
    v_mfma_f32_16x16x32_bf16 v[40:43], a[44:47], a[116:119], v[40:43]
    ds_read_b64_tr_b16 a[20:21], v130 offset:57344
    v_and_b32 v165, 1, v160
    v_mfma_f32_16x16x32_bf16 v[44:47], a[40:43], a[120:123], v[44:47]
    ds_read_b64_tr_b16 a[22:23], v130 offset:58368
    s_add_u32 s88, s88, 128
    v_mfma_f32_16x16x32_bf16 v[44:47], a[44:47], a[124:127], v[44:47]
    ds_read_b64_tr_b16 a[24:25], v131 offset:49152
    s_add_u32 m0, s79, 24576
    v_mfma_f32_16x16x32_bf16 v[112:115], a[48:51], a[96:99], v[112:115]
    buffer_load_dwordx4 v140, s[20:23], s88 offen offset:0 lds
    v_mfma_f32_16x16x32_bf16 v[112:115], a[52:55], a[100:103], v[112:115]
    ds_read_b64_tr_b16 a[26:27], v131 offset:50176
    v_xor_b32 v166, s78, v165
    v_mfma_f32_16x16x32_bf16 v[116:119], a[48:51], a[104:107], v[116:119]
    ds_read_b64_tr_b16 a[28:29], v131 offset:57344
    v_lshl_add_u32 v229, v166, 5, v167
    v_mfma_f32_16x16x32_bf16 v[116:119], a[52:55], a[108:111], v[116:119]
    ds_read_b64_tr_b16 a[30:31], v131 offset:58368
    v_add_u32 v229, 256, v229
    v_mfma_f32_16x16x32_bf16 v[120:123], a[48:51], a[112:115], v[120:123]
    buffer_load_dwordx4 v141, s[20:23], s88 offen offset:1024 lds
    v_mfma_f32_16x16x32_bf16 v[120:123], a[52:55], a[116:119], v[120:123]
    ds_read_b128 a[80:83], v136 offset:49152
    v_add_u32 v253, 73728, v229
    v_mfma_f32_16x16x32_bf16 v[124:127], a[48:51], a[120:123], v[124:127]
    ds_read_b128 a[84:87], v137 offset:49152
    s_lshl_b32 s3, s78, 6
    v_mfma_f32_16x16x32_bf16 v[124:127], a[52:55], a[124:127], v[124:127]
    ds_read_b128 a[88:91], v136 offset:51200
    v_add_u32 v167, s3, v167
    v_mfma_f32_16x16x32_bf16 v[48:51], a[56:59], a[96:99], v[48:51]
    ds_read_b128 a[92:95], v137 offset:51200
    v_lshlrev_b32 v165, 5, v165
    v_mfma_f32_16x16x32_bf16 v[48:51], a[60:63], a[100:103], v[48:51]
    buffer_load_dwordx4 v142, s[20:23], s88 offen offset:2048 lds
    v_mfma_f32_16x16x32_bf16 v[52:55], a[56:59], a[104:107], v[52:55]
    v_add_u32 v247, v167, v165
    v_sub_u32 v248, v167, v165
    v_mfma_f32_16x16x32_bf16 v[52:55], a[60:63], a[108:111], v[52:55]
    v_xor_b32 v244, 64, v243
    v_add_u32 v249, 73728, v247
    v_mfma_f32_16x16x32_bf16 v[56:59], a[56:59], a[112:115], v[56:59]
    v_add_u32 v245, 73728, v243
    v_add_u32 v250, 73728, v248
    v_mfma_f32_16x16x32_bf16 v[56:59], a[60:63], a[116:119], v[56:59]
    buffer_load_dwordx4 v143, s[20:23], s88 offen offset:3072 lds
    v_mfma_f32_16x16x32_bf16 v[60:63], a[56:59], a[120:123], v[60:63]
    v_add_u32 v246, 73728, v244
    s_lshr_b32 s5, s74, 1
    v_mfma_f32_16x16x32_bf16 v[60:63], a[60:63], a[124:127], v[60:63]
    s_xor_b32 s5, s5, s72
    s_lshl_b32 s3, s75, 2
    s_waitcnt vmcnt(21) lgkmcnt(0)
    s_barrier
    s_bfe_u32 s66, s68, 0x40014
    v_mfma_f32_16x16x32_bf16 v[64:67], a[0:3], a[64:67], v[64:67]
    ds_read_b64_tr_b16 a[32:33], v132 offset:0
    s_lshl_b32 s66, s66, 7
    v_mfma_f32_16x16x32_bf16 v[64:67], a[4:7], a[68:71], v[64:67]
    ds_read_b64_tr_b16 a[34:35], v132 offset:1024
    ds_read_b64_tr_b16 a[36:37], v132 offset:8192
    s_add_u32 s89, s84, s66
    v_mfma_f32_16x16x32_bf16 v[68:71], a[0:3], a[72:75], v[68:71]
    ds_read_b64_tr_b16 a[38:39], v132 offset:9216
    s_add_u32 m0, s80, 24576
    v_mfma_f32_16x16x32_bf16 v[68:71], a[4:7], a[76:79], v[68:71]
    buffer_load_dwordx4 v144, s[8:11], s89 offen offset:0 lds
    v_mfma_f32_16x16x32_bf16 v[72:75], a[0:3], a[80:83], v[72:75]
    ds_read_b64_tr_b16 a[40:41], v133 offset:0
    s_add_u32 s3, s3, s5
    v_mfma_f32_16x16x32_bf16 v[72:75], a[4:7], a[84:87], v[72:75]
    ds_read_b64_tr_b16 a[42:43], v133 offset:1024
    ds_read_b64_tr_b16 a[44:45], v133 offset:8192
    s_lshl_b32 s3, s3, 18
    v_mfma_f32_16x16x32_bf16 v[76:79], a[0:3], a[88:91], v[76:79]
    ds_read_b64_tr_b16 a[46:47], v133 offset:9216
    s_lshl_b32 s4, s74, 16
    v_mfma_f32_16x16x32_bf16 v[76:79], a[4:7], a[92:95], v[76:79]
    buffer_load_dwordx4 v145, s[8:11], s89 offen offset:1024 lds
    v_mfma_f32_16x16x32_bf16 v[0:3], a[8:11], a[64:67], v[0:3]
    ds_read_b64_tr_b16 a[48:49], v134 offset:0
    s_add_u32 s3, s3, s4
    v_mfma_f32_16x16x32_bf16 v[0:3], a[12:15], a[68:71], v[0:3]
    ds_read_b64_tr_b16 a[50:51], v134 offset:1024
    ds_read_b64_tr_b16 a[52:53], v134 offset:8192
    s_bfe_u32 s88, s68, 0x40014
    v_mfma_f32_16x16x32_bf16 v[4:7], a[8:11], a[72:75], v[4:7]
    ds_read_b64_tr_b16 a[54:55], v134 offset:9216
    s_lshl_b32 s88, s88, 19
    v_mfma_f32_16x16x32_bf16 v[4:7], a[12:15], a[76:79], v[4:7]
    ds_read_b64_tr_b16 a[56:57], v135 offset:0
    s_add_u32 m0, s79, 49152
    v_mfma_f32_16x16x32_bf16 v[8:11], a[8:11], a[80:83], v[8:11]
    buffer_load_dwordx4 v140, s[20:23], s88 offen offset:0 lds
    v_mfma_f32_16x16x32_bf16 v[8:11], a[12:15], a[84:87], v[8:11]
    ds_read_b64_tr_b16 a[58:59], v135 offset:1024
    ds_read_b64_tr_b16 a[60:61], v135 offset:8192
    v_lshrrev_b32 v165, 3, v164
    v_mfma_f32_16x16x32_bf16 v[12:15], a[8:11], a[88:91], v[12:15]
    ds_read_b64_tr_b16 a[62:63], v135 offset:9216
    v_lshlrev_b32 v165, 8, v165
    v_mfma_f32_16x16x32_bf16 v[12:15], a[12:15], a[92:95], v[12:15]
    ds_read_b128 a[96:99], v138 offset:0
    v_add_u32 v165, s3, v165
    v_mfma_f32_16x16x32_bf16 v[80:83], a[16:19], a[64:67], v[80:83]
    buffer_load_dwordx4 v141, s[20:23], s88 offen offset:1024 lds
    v_mfma_f32_16x16x32_bf16 v[80:83], a[20:23], a[68:71], v[80:83]
    ds_read_b128 a[100:103], v139 offset:0
    ds_read_b128 a[104:107], v138 offset:2048
    v_and_b32 v166, 7, v164
    v_mfma_f32_16x16x32_bf16 v[84:87], a[16:19], a[72:75], v[84:87]
    ds_read_b128 a[108:111], v139 offset:2048
    v_xor_b32 v166, v166, v160
    v_mfma_f32_16x16x32_bf16 v[84:87], a[20:23], a[76:79], v[84:87]
    ds_read_b64 a[192:193], v150
    v_lshl_add_u32 v234, v166, 4, v165
    v_mfma_f32_16x16x32_bf16 v[88:91], a[16:19], a[80:83], v[88:91]
    buffer_load_dwordx4 v142, s[20:23], s88 offen offset:2048 lds
    v_mfma_f32_16x16x32_bf16 v[88:91], a[20:23], a[84:87], v[88:91]
    ds_read_b64 a[194:195], v151
    ds_read_b64 a[196:197], v152
    v_xor_b32 v235, 64, v234
    v_mfma_f32_16x16x32_bf16 v[92:95], a[16:19], a[88:91], v[92:95]
    ds_read_b64 a[198:199], v153
    v_add_u32 v235, 1024, v235
    v_mfma_f32_16x16x32_bf16 v[92:95], a[20:23], a[92:95], v[92:95]
    ds_read_b64 a[200:201], v154
    v_add_u32 v236, 2048, v234
    v_mfma_f32_16x16x32_bf16 v[16:19], a[24:27], a[64:67], v[16:19]
    ds_read_b64 a[202:203], v155
    ds_read_b64 a[204:205], v156
    v_add_u32 v237, 2048, v235
    v_mfma_f32_16x16x32_bf16 v[16:19], a[28:31], a[68:71], v[16:19]
    buffer_load_dwordx4 v143, s[20:23], s88 offen offset:3072 lds
    v_mfma_f32_16x16x32_bf16 v[20:23], a[24:27], a[72:75], v[20:23]
    ds_read_b64 a[206:207], v157
    s_lshl_b32 s3, s74, 10
    v_mfma_f32_16x16x32_bf16 v[20:23], a[28:31], a[76:79], v[20:23]
    s_add_u32 s89, s85, s66
    s_lshl_b32 s4, s72, 4
    v_mfma_f32_16x16x32_bf16 v[24:27], a[24:27], a[80:83], v[24:27]
    s_add_u32 m0, s80, 49152
    s_add_u32 s3, s3, s4
    v_mfma_f32_16x16x32_bf16 v[24:27], a[28:31], a[84:87], v[24:27]
    buffer_load_dwordx4 v144, s[8:11], s89 offen offset:0 lds
    v_mfma_f32_16x16x32_bf16 v[28:31], a[24:27], a[88:91], v[28:31]
    s_mul_i32 s3, s3, 1280
    s_mul_i32 s4, s76, 320
    v_mfma_f32_16x16x32_bf16 v[28:31], a[28:31], a[92:95], v[28:31]
    s_add_u32 s3, s3, s4
    s_and_b32 s5, s74, 1
    s_waitcnt vmcnt(23) lgkmcnt(0)
    s_barrier
    v_mfma_f32_16x16x32_bf16 v[96:99], a[32:35], a[64:67], v[96:99]
    ds_read_b64_tr_b16 a[0:1], v132 offset:24576
    s_add_u32 s90, s86, 4096
    v_mfma_f32_16x16x32_bf16 v[96:99], a[36:39], a[68:71], v[96:99]
    ds_read_b64_tr_b16 a[2:3], v132 offset:25600
    s_mov_b32 m0, s82
    v_mfma_f32_16x16x32_bf16 v[100:103], a[32:35], a[72:75], v[100:103]
    buffer_load_dwordx4 v146, s[12:15], s90 offen offset:0 lds
    v_mfma_f32_16x16x32_bf16 v[100:103], a[36:39], a[76:79], v[100:103]
    ds_read_b64_tr_b16 a[4:5], v132 offset:32768
    ds_read_b64_tr_b16 a[6:7], v132 offset:33792
    s_mul_i32 s4, s5, 0x2222
    v_mfma_f32_16x16x32_bf16 v[104:107], a[32:35], a[80:83], v[104:107]
    buffer_load_dwordx4 v147, s[12:15], s90 offen offset:1024 lds
    v_mfma_f32_16x16x32_bf16 v[104:107], a[36:39], a[84:87], v[104:107]
    ds_read_b64_tr_b16 a[8:9], v133 offset:24576
    s_xor_b32 s6, s4, 0x43210
    v_mfma_f32_16x16x32_bf16 v[108:111], a[32:35], a[88:91], v[108:111]
    ds_read_b64_tr_b16 a[10:11], v133 offset:25600
    s_and_b32 s4, s76, 1
    v_mfma_f32_16x16x32_bf16 v[108:111], a[36:39], a[92:95], v[108:111]
    buffer_load_dwordx4 v148, s[12:15], s90 offen offset:2048 lds
    v_mfma_f32_16x16x32_bf16 v[32:35], a[40:43], a[64:67], v[32:35]
    ds_read_b64_tr_b16 a[12:13], v133 offset:32768
    s_mul_i32 s4, s4, 0xfffc1111
    v_mfma_f32_16x16x32_bf16 v[32:35], a[44:47], a[68:71], v[32:35]
    ds_read_b64_tr_b16 a[14:15], v133 offset:33792
    s_add_u32 s6, s6, s4
    v_mfma_f32_16x16x32_bf16 v[36:39], a[40:43], a[72:75], v[36:39]
    buffer_load_dwordx4 v149, s[12:15], s90 offen offset:3072 lds
    v_mfma_f32_16x16x32_bf16 v[36:39], a[44:47], a[76:79], v[36:39]
    ds_read_b64_tr_b16 a[16:17], v134 offset:24576
    s_add_u32 m0, s80, 49152
    v_mfma_f32_16x16x32_bf16 v[40:43], a[40:43], a[80:83], v[40:43]
    buffer_load_dwordx4 v145, s[8:11], s89 offen offset:1024 lds
    v_mfma_f32_16x16x32_bf16 v[40:43], a[44:47], a[84:87], v[40:43]
    ds_read_b64_tr_b16 a[18:19], v134 offset:25600
    ds_read_b64_tr_b16 a[20:21], v134 offset:32768
    s_add_u32 s88, s88, 128
    v_mfma_f32_16x16x32_bf16 v[44:47], a[40:43], a[88:91], v[44:47]
    ds_read_b64_tr_b16 a[22:23], v134 offset:33792
    s_add_u32 m0, s79, 73728
    v_mfma_f32_16x16x32_bf16 v[44:47], a[44:47], a[92:95], v[44:47]
L_pad1:
    s_cbranch_execz L_main
    buffer_load_dwordx4 v140, s[20:23], s88 offen offset:0 lds
    v_mfma_f32_16x16x32_bf16 v[112:115], a[48:51], a[64:67], v[112:115]
    ds_read_b64_tr_b16 a[24:25], v135 offset:24576
    v_add_u32 v165, 0, v164
    v_mfma_f32_16x16x32_bf16 v[112:115], a[52:55], a[68:71], v[112:115]
    buffer_load_dwordx4 v141, s[20:23], s88 offen offset:1024 lds
    v_mfma_f32_16x16x32_bf16 v[116:119], a[48:51], a[72:75], v[116:119]
    ds_read_b64_tr_b16 a[26:27], v135 offset:25600
    v_mul_u32_u24 v166, 3277, v165
    v_mfma_f32_16x16x32_bf16 v[116:119], a[52:55], a[76:79], v[116:119]
    ds_read_b64_tr_b16 a[28:29], v135 offset:32768
    v_lshrrev_b32 v166, 16, v166
    v_mfma_f32_16x16x32_bf16 v[120:123], a[48:51], a[80:83], v[120:123]
    buffer_load_dwordx4 v142, s[20:23], s88 offen offset:2048 lds
    v_mfma_f32_16x16x32_bf16 v[120:123], a[52:55], a[84:87], v[120:123]
    ds_read_b64_tr_b16 a[30:31], v135 offset:33792
    v_mul_u32_u24 v167, 20, v166
    v_mfma_f32_16x16x32_bf16 v[124:127], a[48:51], a[88:91], v[124:127]
    buffer_load_dwordx4 v143, s[20:23], s88 offen offset:3072 lds
    s_bfe_u32 s66, s68, 0x40018
    s_lshl_b32 s66, s66, 7
    v_mfma_f32_16x16x32_bf16 v[124:127], a[52:55], a[92:95], v[124:127]
    ds_read_b128 a[112:115], v138 offset:24576
    ds_read_b128 a[116:119], v139 offset:24576
    s_add_u32 s89, s84, s66
    v_mfma_f32_16x16x32_bf16 v[48:51], a[56:59], a[64:67], v[48:51]
    ds_read_b128 a[120:123], v138 offset:26624
    s_add_u32 m0, s80, 73728
    v_mfma_f32_16x16x32_bf16 v[48:51], a[60:63], a[68:71], v[48:51]
    buffer_load_dwordx4 v144, s[8:11], s89 offen offset:0 lds
    v_mfma_f32_16x16x32_bf16 v[52:55], a[56:59], a[72:75], v[52:55]
    ds_read_b128 a[124:127], v139 offset:26624
    v_sub_u32 v165, v165, v167
    v_mfma_f32_16x16x32_bf16 v[52:55], a[60:63], a[76:79], v[52:55]
    v_bfe_u32 v167, v166, 3, 1
    v_lshlrev_b32 v167, 1, v167
    v_mfma_f32_16x16x32_bf16 v[56:59], a[56:59], a[80:83], v[56:59]
    buffer_load_dwordx4 v145, s[8:11], s89 offen offset:1024 lds
    v_mfma_f32_16x16x32_bf16 v[56:59], a[60:63], a[84:87], v[56:59]
    v_xor_b32 v165, v165, v167
    v_and_b32 v167, 28, v165
    v_mfma_f32_16x16x32_bf16 v[60:63], a[56:59], a[88:91], v[60:63]
    buffer_load_dwordx2 v[230:231], v255, s[32:35], s98 offen sc1
    v_mfma_f32_16x16x32_bf16 v[60:63], a[60:63], a[92:95], v[60:63]
    v_bfe_u32 v167, s6, v167, 3
    v_and_b32 v165, 3, v165
    s_waitcnt vmcnt(29) lgkmcnt(0)
    s_barrier
    v_mfma_f32_16x16x32_bf16 v[64:67], a[0:3], a[96:99], v[64:67]
    ds_read_b64_tr_b16 a[32:33], v132 offset:49152
    s_bfe_u32 s88, s68, 0x40018
    v_mfma_f32_16x16x32_bf16 v[64:67], a[4:7], a[100:103], v[64:67]
    ds_read_b64_tr_b16 a[34:35], v132 offset:50176
    s_lshl_b32 s88, s88, 19
    v_mfma_f32_16x16x32_bf16 v[68:71], a[0:3], a[104:107], v[68:71]
    ds_read_b64_tr_b16 a[36:37], v132 offset:57344
    s_add_u32 m0, s79, 98304
    v_mfma_f32_16x16x32_bf16 v[68:71], a[4:7], a[108:111], v[68:71]
    buffer_load_dwordx4 v140, s[20:23], s88 offen offset:0 lds
    v_mfma_f32_16x16x32_bf16 v[72:75], a[0:3], a[112:115], v[72:75]
    ds_read_b64_tr_b16 a[38:39], v132 offset:58368
    v_lshl_add_u32 v165, v167, 2, v165
    v_mfma_f32_16x16x32_bf16 v[72:75], a[4:7], a[116:119], v[72:75]
    ds_read_b64_tr_b16 a[40:41], v133 offset:49152
    v_mul_u32_u24 v166, 1280, v166
    v_mfma_f32_16x16x32_bf16 v[76:79], a[0:3], a[120:123], v[76:79]
    ds_read_b64_tr_b16 a[42:43], v133 offset:50176
    v_lshl_add_u32 v238, v165, 4, v166
    v_mfma_f32_16x16x32_bf16 v[76:79], a[4:7], a[124:127], v[76:79]
    ds_read_b64_tr_b16 a[44:45], v133 offset:57344
    v_add_u32 v238, s3, v238
    v_mfma_f32_16x16x32_bf16 v[0:3], a[8:11], a[96:99], v[0:3]
    buffer_load_dwordx4 v141, s[20:23], s88 offen offset:1024 lds
    v_mfma_f32_16x16x32_bf16 v[0:3], a[12:15], a[100:103], v[0:3]
    ds_read_b64_tr_b16 a[46:47], v133 offset:58368
    v_add_u32 v165, 64, v164
    v_mfma_f32_16x16x32_bf16 v[4:7], a[8:11], a[104:107], v[4:7]
    ds_read_b64_tr_b16 a[48:49], v134 offset:49152
    v_mul_u32_u24 v166, 3277, v165
    v_mfma_f32_16x16x32_bf16 v[4:7], a[12:15], a[108:111], v[4:7]
    ds_read_b64_tr_b16 a[50:51], v134 offset:50176
    v_lshrrev_b32 v166, 16, v166
    v_mfma_f32_16x16x32_bf16 v[8:11], a[8:11], a[112:115], v[8:11]
    ds_read_b64_tr_b16 a[52:53], v134 offset:57344
    v_mul_u32_u24 v167, 20, v166
    v_mfma_f32_16x16x32_bf16 v[8:11], a[12:15], a[116:119], v[8:11]
    buffer_load_dwordx4 v142, s[20:23], s88 offen offset:2048 lds
    v_mfma_f32_16x16x32_bf16 v[12:15], a[8:11], a[120:123], v[12:15]
    ds_read_b64_tr_b16 a[54:55], v134 offset:58368
    v_sub_u32 v165, v165, v167
    v_mfma_f32_16x16x32_bf16 v[12:15], a[12:15], a[124:127], v[12:15]
    ds_read_b64_tr_b16 a[56:57], v135 offset:49152
    v_bfe_u32 v167, v166, 3, 1
    v_mfma_f32_16x16x32_bf16 v[80:83], a[16:19], a[96:99], v[80:83]
    ds_read_b64_tr_b16 a[58:59], v135 offset:50176
    v_lshlrev_b32 v167, 1, v167
    v_mfma_f32_16x16x32_bf16 v[80:83], a[20:23], a[100:103], v[80:83]
    ds_read_b64_tr_b16 a[60:61], v135 offset:57344
    v_xor_b32 v165, v165, v167
    v_mfma_f32_16x16x32_bf16 v[84:87], a[16:19], a[104:107], v[84:87]
    ds_read_b64_tr_b16 a[62:63], v135 offset:58368
    v_and_b32 v167, 28, v165
    v_mfma_f32_16x16x32_bf16 v[84:87], a[20:23], a[108:111], v[84:87]
    buffer_load_dwordx4 v143, s[20:23], s88 offen offset:3072 lds
    v_mfma_f32_16x16x32_bf16 v[88:91], a[16:19], a[112:115], v[88:91]
    ds_read_b128 a[64:67], v138 offset:49152
    v_bfe_u32 v167, s6, v167, 3
    v_mfma_f32_16x16x32_bf16 v[88:91], a[20:23], a[116:119], v[88:91]
    ds_read_b128 a[68:71], v139 offset:49152
    v_and_b32 v165, 3, v165
    v_mfma_f32_16x16x32_bf16 v[92:95], a[16:19], a[120:123], v[92:95]
    ds_read_b128 a[72:75], v138 offset:51200
    s_add_u32 s89, s85, s66
    v_mfma_f32_16x16x32_bf16 v[92:95], a[20:23], a[124:127], v[92:95]
    ds_read_b128 a[76:79], v139 offset:51200
    s_add_u32 m0, s80, 98304
    v_mfma_f32_16x16x32_bf16 v[16:19], a[24:27], a[96:99], v[16:19]
    buffer_load_dwordx4 v144, s[8:11], s89 offen offset:0 lds
    v_mfma_f32_16x16x32_bf16 v[16:19], a[28:31], a[100:103], v[16:19]
    v_lshl_add_u32 v165, v167, 2, v165
    v_mul_u32_u24 v166, 1280, v166
    v_mfma_f32_16x16x32_bf16 v[20:23], a[24:27], a[104:107], v[20:23]
    v_lshl_add_u32 v239, v165, 4, v166
    v_add_u32 v239, s3, v239
    v_mfma_f32_16x16x32_bf16 v[20:23], a[28:31], a[108:111], v[20:23]
    v_subrev_u32 v239, 1024, v239
    v_add_u32 v165, 128, v164
    v_mfma_f32_16x16x32_bf16 v[24:27], a[24:27], a[112:115], v[24:27]
    v_mul_u32_u24 v166, 3277, v165
    v_lshrrev_b32 v166, 16, v166
    v_mfma_f32_16x16x32_bf16 v[24:27], a[28:31], a[116:119], v[24:27]
    buffer_load_dwordx4 v145, s[8:11], s89 offen offset:1024 lds
    v_mfma_f32_16x16x32_bf16 v[28:31], a[24:27], a[120:123], v[28:31]
    v_mul_u32_u24 v167, 20, v166
    v_sub_u32 v165, v165, v167
    v_mfma_f32_16x16x32_bf16 v[28:31], a[28:31], a[124:127], v[28:31]
    v_bfe_u32 v167, v166, 3, 1
    v_lshlrev_b32 v167, 1, v167
    s_waitcnt vmcnt(29) lgkmcnt(0)
    s_barrier
    v_mfma_f32_16x16x32_bf16 v[96:99], a[32:35], a[96:99], v[96:99]
    ds_read_b64_tr_b16 a[0:1], v128 offset:0
    v_xor_b32 v165, v165, v167
    v_mfma_f32_16x16x32_bf16 v[96:99], a[36:39], a[100:103], v[96:99]
    ds_read_b64_tr_b16 a[2:3], v128 offset:1024
    s_add_u32 s88, s88, 128
    v_mfma_f32_16x16x32_bf16 v[100:103], a[32:35], a[104:107], v[100:103]
    ds_read_b64_tr_b16 a[4:5], v128 offset:8192
    s_add_u32 m0, s79, 122880
    v_mfma_f32_16x16x32_bf16 v[100:103], a[36:39], a[108:111], v[100:103]
    buffer_load_dwordx4 v140, s[20:23], s88 offen offset:0 lds
    v_mfma_f32_16x16x32_bf16 v[104:107], a[32:35], a[112:115], v[104:107]
    ds_read_b64_tr_b16 a[6:7], v128 offset:9216
    v_and_b32 v167, 28, v165
    v_mfma_f32_16x16x32_bf16 v[104:107], a[36:39], a[116:119], v[104:107]
    ds_read_b64_tr_b16 a[8:9], v129 offset:0
    v_bfe_u32 v167, s6, v167, 3
    v_mfma_f32_16x16x32_bf16 v[108:111], a[32:35], a[120:123], v[108:111]
    ds_read_b64_tr_b16 a[10:11], v129 offset:1024
    v_and_b32 v165, 3, v165
    v_mfma_f32_16x16x32_bf16 v[108:111], a[36:39], a[124:127], v[108:111]
    ds_read_b64_tr_b16 a[12:13], v129 offset:8192
    v_lshl_add_u32 v165, v167, 2, v165
    v_mfma_f32_16x16x32_bf16 v[32:35], a[40:43], a[96:99], v[32:35]
    buffer_load_dwordx4 v141, s[20:23], s88 offen offset:1024 lds
    v_mfma_f32_16x16x32_bf16 v[32:35], a[44:47], a[100:103], v[32:35]
    ds_read_b64_tr_b16 a[14:15], v129 offset:9216
    v_mul_u32_u24 v166, 1280, v166
    v_mfma_f32_16x16x32_bf16 v[36:39], a[40:43], a[104:107], v[36:39]
    ds_read_b64_tr_b16 a[16:17], v130 offset:0
    v_lshl_add_u32 v240, v165, 4, v166
    v_mfma_f32_16x16x32_bf16 v[36:39], a[44:47], a[108:111], v[36:39]
    ds_read_b64_tr_b16 a[18:19], v130 offset:1024
    v_add_u32 v240, s3, v240
    v_mfma_f32_16x16x32_bf16 v[40:43], a[40:43], a[112:115], v[40:43]
    ds_read_b64_tr_b16 a[20:21], v130 offset:8192
    v_subrev_u32 v240, 2048, v240
    v_mfma_f32_16x16x32_bf16 v[40:43], a[44:47], a[116:119], v[40:43]
    buffer_load_dwordx4 v142, s[20:23], s88 offen offset:2048 lds
    v_mfma_f32_16x16x32_bf16 v[44:47], a[40:43], a[120:123], v[44:47]
    ds_read_b64_tr_b16 a[22:23], v130 offset:9216
    v_add_u32 v165, 192, v164
    v_mfma_f32_16x16x32_bf16 v[44:47], a[44:47], a[124:127], v[44:47]
    ds_read_b64_tr_b16 a[24:25], v131 offset:0
    v_mul_u32_u24 v166, 3277, v165
    v_mfma_f32_16x16x32_bf16 v[112:115], a[48:51], a[96:99], v[112:115]
    ds_read_b64_tr_b16 a[26:27], v131 offset:1024
    v_lshrrev_b32 v166, 16, v166
    v_mfma_f32_16x16x32_bf16 v[112:115], a[52:55], a[100:103], v[112:115]
    ds_read_b64_tr_b16 a[28:29], v131 offset:8192
    v_mul_u32_u24 v167, 20, v166
    v_mfma_f32_16x16x32_bf16 v[116:119], a[48:51], a[104:107], v[116:119]
    ds_read_b64_tr_b16 a[30:31], v131 offset:9216
    v_sub_u32 v165, v165, v167
    v_mfma_f32_16x16x32_bf16 v[116:119], a[52:55], a[108:111], v[116:119]
    buffer_load_dwordx4 v143, s[20:23], s88 offen offset:3072 lds
    v_mfma_f32_16x16x32_bf16 v[120:123], a[48:51], a[112:115], v[120:123]
    ds_read_b128 a[80:83], v136 offset:0
    s_bfe_u32 s66, s68, 0x4001c
    v_mfma_f32_16x16x32_bf16 v[120:123], a[52:55], a[116:119], v[120:123]
    ds_read_b128 a[84:87], v137 offset:0
    s_lshl_b32 s66, s66, 7
    v_mfma_f32_16x16x32_bf16 v[124:127], a[48:51], a[120:123], v[124:127]
    ds_read_b128 a[88:91], v136 offset:2048
    s_add_u32 s89, s84, s66
    v_mfma_f32_16x16x32_bf16 v[124:127], a[52:55], a[124:127], v[124:127]
    ds_read_b128 a[92:95], v137 offset:2048
    s_add_u32 m0, s80, 122880
    v_mfma_f32_16x16x32_bf16 v[48:51], a[56:59], a[96:99], v[48:51]
    buffer_load_dwordx4 v144, s[8:11], s89 offen offset:0 lds
    v_mfma_f32_16x16x32_bf16 v[48:51], a[60:63], a[100:103], v[48:51]
    v_bfe_u32 v167, v166, 3, 1
    v_lshlrev_b32 v167, 1, v167
    v_mfma_f32_16x16x32_bf16 v[52:55], a[56:59], a[104:107], v[52:55]
    v_xor_b32 v165, v165, v167
    v_and_b32 v167, 28, v165
    v_mfma_f32_16x16x32_bf16 v[52:55], a[60:63], a[108:111], v[52:55]
    v_bfe_u32 v167, s6, v167, 3
    v_and_b32 v165, 3, v165
    v_mfma_f32_16x16x32_bf16 v[56:59], a[56:59], a[112:115], v[56:59]
    v_lshl_add_u32 v165, v167, 2, v165
    v_mul_u32_u24 v166, 1280, v166
    v_mfma_f32_16x16x32_bf16 v[56:59], a[60:63], a[116:119], v[56:59]
    buffer_load_dwordx4 v145, s[8:11], s89 offen offset:1024 lds
    v_mfma_f32_16x16x32_bf16 v[60:63], a[56:59], a[120:123], v[60:63]
    v_lshl_add_u32 v241, v165, 4, v166
    v_add_u32 v241, s3, v241
    v_mfma_f32_16x16x32_bf16 v[60:63], a[60:63], a[124:127], v[60:63]
    v_subrev_u32 v241, 3072, v241
    v_add_u32 v165, 256, v164
    s_waitcnt vmcnt(20) lgkmcnt(0)
    s_barrier
    v_mfma_f32_16x16x32_bf16 v[64:67], a[0:3], a[64:67], v[64:67]
    ds_read_b64_tr_b16 a[32:33], v128 offset:24576
    s_bfe_u32 s88, s68, 0x4001c
    v_mfma_f32_16x16x32_bf16 v[64:67], a[4:7], a[68:71], v[64:67]
    ds_read_b64_tr_b16 a[34:35], v128 offset:25600
    ds_read_b64_tr_b16 a[36:37], v128 offset:32768
    s_lshl_b32 s88, s88, 19
    v_mfma_f32_16x16x32_bf16 v[68:71], a[0:3], a[72:75], v[68:71]
    ds_read_b64_tr_b16 a[38:39], v128 offset:33792
    s_add_u32 m0, s79, 0
    v_mfma_f32_16x16x32_bf16 v[68:71], a[4:7], a[76:79], v[68:71]
    buffer_load_dwordx4 v140, s[20:23], s88 offen offset:0 lds
    v_mfma_f32_16x16x32_bf16 v[72:75], a[0:3], a[80:83], v[72:75]
    ds_read_b64_tr_b16 a[40:41], v129 offset:24576
    v_mul_u32_u24 v166, 3277, v165
    v_mfma_f32_16x16x32_bf16 v[72:75], a[4:7], a[84:87], v[72:75]
    ds_read_b64_tr_b16 a[42:43], v129 offset:25600
    v_lshrrev_b32 v166, 16, v166
    v_mfma_f32_16x16x32_bf16 v[76:79], a[0:3], a[88:91], v[76:79]
    ds_read_b64_tr_b16 a[44:45], v129 offset:32768
    ds_read_b64_tr_b16 a[46:47], v129 offset:33792
    v_mul_u32_u24 v167, 20, v166
    v_mfma_f32_16x16x32_bf16 v[76:79], a[4:7], a[92:95], v[76:79]
    ds_read_b64_tr_b16 a[48:49], v130 offset:24576
    v_sub_u32 v165, v165, v167
    v_mfma_f32_16x16x32_bf16 v[0:3], a[8:11], a[64:67], v[0:3]
    buffer_load_dwordx4 v141, s[20:23], s88 offen offset:1024 lds
    v_mfma_f32_16x16x32_bf16 v[0:3], a[12:15], a[68:71], v[0:3]
    ds_read_b64_tr_b16 a[50:51], v130 offset:25600
    v_bfe_u32 v167, v166, 3, 1
    v_mfma_f32_16x16x32_bf16 v[4:7], a[8:11], a[72:75], v[4:7]
    ds_read_b64_tr_b16 a[52:53], v130 offset:32768
    v_lshlrev_b32 v167, 1, v167
    v_mfma_f32_16x16x32_bf16 v[4:7], a[12:15], a[76:79], v[4:7]
    ds_read_b64_tr_b16 a[54:55], v130 offset:33792
    ds_read_b64_tr_b16 a[56:57], v131 offset:24576
    v_xor_b32 v165, v165, v167
    v_mfma_f32_16x16x32_bf16 v[8:11], a[8:11], a[80:83], v[8:11]
    ds_read_b64_tr_b16 a[58:59], v131 offset:25600
    v_and_b32 v167, 28, v165
    v_mfma_f32_16x16x32_bf16 v[8:11], a[12:15], a[84:87], v[8:11]
    buffer_load_dwordx4 v142, s[20:23], s88 offen offset:2048 lds
    v_mfma_f32_16x16x32_bf16 v[12:15], a[8:11], a[88:91], v[12:15]
    ds_read_b64_tr_b16 a[60:61], v131 offset:32768
    v_bfe_u32 v167, s6, v167, 3
    v_mfma_f32_16x16x32_bf16 v[12:15], a[12:15], a[92:95], v[12:15]
    ds_read_b64_tr_b16 a[62:63], v131 offset:33792
    ds_read_b128 a[96:99], v136 offset:24576
    v_and_b32 v165, 3, v165
    v_mfma_f32_16x16x32_bf16 v[80:83], a[16:19], a[64:67], v[80:83]
    ds_read_b128 a[100:103], v137 offset:24576
    v_lshl_add_u32 v165, v167, 2, v165
    v_mfma_f32_16x16x32_bf16 v[80:83], a[20:23], a[68:71], v[80:83]
    ds_read_b128 a[104:107], v136 offset:26624
    v_mul_u32_u24 v166, 1280, v166
    v_mfma_f32_16x16x32_bf16 v[84:87], a[16:19], a[72:75], v[84:87]
    ds_read_b128 a[108:111], v137 offset:26624
    v_lshl_add_u32 v242, v165, 4, v166
    v_mfma_f32_16x16x32_bf16 v[84:87], a[20:23], a[76:79], v[84:87]
    buffer_load_dwordx4 v143, s[20:23], s88 offen offset:3072 lds
    v_mfma_f32_16x16x32_bf16 v[88:91], a[16:19], a[80:83], v[88:91]
    ds_read_b64 a[208:209], v150
    ds_read_b64 a[210:211], v151
    v_add_u32 v242, s3, v242
    v_mfma_f32_16x16x32_bf16 v[88:91], a[20:23], a[84:87], v[88:91]
    ds_read_b64 a[212:213], v152
    s_bfe_u32 s3, s70, 0x40000
    v_mfma_f32_16x16x32_bf16 v[92:95], a[16:19], a[88:91], v[92:95]
    ds_read_b64 a[214:215], v153
    s_add_u32 s89, s85, s66
    v_mfma_f32_16x16x32_bf16 v[92:95], a[20:23], a[92:95], v[92:95]
    ds_read_b64 a[216:217], v154
    s_add_u32 m0, s80, 0
    v_mfma_f32_16x16x32_bf16 v[16:19], a[24:27], a[64:67], v[16:19]
    buffer_load_dwordx4 v144, s[8:11], s89 offen offset:0 lds
    v_mfma_f32_16x16x32_bf16 v[16:19], a[28:31], a[68:71], v[16:19]
    ds_read_b64 a[218:219], v155
    ds_read_b64 a[220:221], v156
    s_lshl_b32 s40, s3, 13
    v_mfma_f32_16x16x32_bf16 v[20:23], a[24:27], a[72:75], v[20:23]
    ds_read_b64 a[222:223], v157
    s_mul_i32 s48, s3, 163840
    v_mfma_f32_16x16x32_bf16 v[20:23], a[28:31], a[76:79], v[20:23]
    s_add_u32 s49, s48, 81920
    s_bfe_u32 s3, s70, 0x40004
    v_mfma_f32_16x16x32_bf16 v[24:27], a[24:27], a[80:83], v[24:27]
    s_lshl_b32 s41, s3, 13
    s_mul_i32 s50, s3, 163840
    v_mfma_f32_16x16x32_bf16 v[24:27], a[28:31], a[84:87], v[24:27]
    buffer_load_dwordx4 v145, s[8:11], s89 offen offset:1024 lds
    v_mfma_f32_16x16x32_bf16 v[28:31], a[24:27], a[88:91], v[28:31]
    s_add_u32 s51, s50, 81920
    s_bfe_u32 s3, s70, 0x40008
    v_mfma_f32_16x16x32_bf16 v[28:31], a[28:31], a[92:95], v[28:31]
    s_lshl_b32 s42, s3, 13
    s_mul_i32 s52, s3, 163840
    s_waitcnt vmcnt(25) lgkmcnt(0)
    s_barrier
    v_mfma_f32_16x16x32_bf16 v[96:99], a[32:35], a[64:67], v[96:99]
    ds_read_b64_tr_b16 a[0:1], v128 offset:49152
    s_add_u32 s90, s87, 0
    v_mfma_f32_16x16x32_bf16 v[96:99], a[36:39], a[68:71], v[96:99]
    ds_read_b64_tr_b16 a[2:3], v128 offset:50176
    s_mov_b32 m0, s82
    v_mfma_f32_16x16x32_bf16 v[100:103], a[32:35], a[72:75], v[100:103]
    buffer_load_dwordx4 v146, s[12:15], s90 offen offset:0 lds
    v_mfma_f32_16x16x32_bf16 v[100:103], a[36:39], a[76:79], v[100:103]
    ds_read_b64_tr_b16 a[4:5], v128 offset:57344
    s_add_u32 s53, s52, 81920
    v_mfma_f32_16x16x32_bf16 v[104:107], a[32:35], a[80:83], v[104:107]
    ds_read_b64_tr_b16 a[6:7], v128 offset:58368
    s_bfe_u32 s3, s70, 0x4000c
    v_mfma_f32_16x16x32_bf16 v[104:107], a[36:39], a[84:87], v[104:107]
    buffer_load_dwordx4 v147, s[12:15], s90 offen offset:1024 lds
    v_mfma_f32_16x16x32_bf16 v[108:111], a[32:35], a[88:91], v[108:111]
    ds_read_b64_tr_b16 a[8:9], v129 offset:49152
    s_lshl_b32 s43, s3, 13
    v_mfma_f32_16x16x32_bf16 v[108:111], a[36:39], a[92:95], v[108:111]
    ds_read_b64_tr_b16 a[10:11], v129 offset:50176
    s_mul_i32 s54, s3, 163840
    v_mfma_f32_16x16x32_bf16 v[32:35], a[40:43], a[64:67], v[32:35]
    buffer_load_dwordx4 v148, s[12:15], s90 offen offset:2048 lds
    v_mfma_f32_16x16x32_bf16 v[32:35], a[44:47], a[68:71], v[32:35]
    ds_read_b64_tr_b16 a[12:13], v129 offset:57344
    s_add_u32 s55, s54, 81920
    v_mfma_f32_16x16x32_bf16 v[36:39], a[40:43], a[72:75], v[36:39]
    ds_read_b64_tr_b16 a[14:15], v129 offset:58368
    s_bfe_u32 s3, s70, 0x40010
    v_mfma_f32_16x16x32_bf16 v[36:39], a[44:47], a[76:79], v[36:39]
    buffer_load_dwordx4 v149, s[12:15], s90 offen offset:3072 lds
    v_mfma_f32_16x16x32_bf16 v[40:43], a[40:43], a[80:83], v[40:43]
    ds_read_b64_tr_b16 a[16:17], v130 offset:49152
    s_add_u32 s88, s88, 128
    v_mfma_f32_16x16x32_bf16 v[40:43], a[44:47], a[84:87], v[40:43]
    ds_read_b64_tr_b16 a[18:19], v130 offset:50176
    ds_read_b64_tr_b16 a[20:21], v130 offset:57344
    s_add_u32 m0, s79, 24576
    v_mfma_f32_16x16x32_bf16 v[44:47], a[40:43], a[88:91], v[44:47]
    buffer_load_dwordx4 v140, s[20:23], s88 offen offset:0 lds
    v_mfma_f32_16x16x32_bf16 v[44:47], a[44:47], a[92:95], v[44:47]
    ds_read_b64_tr_b16 a[22:23], v130 offset:58368
    s_lshl_b32 s44, s3, 13
    v_mfma_f32_16x16x32_bf16 v[112:115], a[48:51], a[64:67], v[112:115]
    ds_read_b64_tr_b16 a[24:25], v131 offset:49152
    s_mul_i32 s56, s3, 163840
    v_mfma_f32_16x16x32_bf16 v[112:115], a[52:55], a[68:71], v[112:115]
    ds_read_b64_tr_b16 a[26:27], v131 offset:50176
    s_add_u32 s57, s56, 81920
    v_mfma_f32_16x16x32_bf16 v[116:119], a[48:51], a[72:75], v[116:119]
    buffer_load_dwordx4 v141, s[20:23], s88 offen offset:1024 lds
    v_mfma_f32_16x16x32_bf16 v[116:119], a[52:55], a[76:79], v[116:119]
    ds_read_b64_tr_b16 a[28:29], v131 offset:57344
    s_bfe_u32 s3, s70, 0x40014
    v_mfma_f32_16x16x32_bf16 v[120:123], a[48:51], a[80:83], v[120:123]
    ds_read_b64_tr_b16 a[30:31], v131 offset:58368
    s_lshl_b32 s45, s3, 13
    v_mfma_f32_16x16x32_bf16 v[120:123], a[52:55], a[84:87], v[120:123]
    buffer_load_dwordx4 v142, s[20:23], s88 offen offset:2048 lds
    v_mfma_f32_16x16x32_bf16 v[124:127], a[48:51], a[88:91], v[124:127]
    ds_read_b128 a[112:115], v136 offset:49152
    s_mul_i32 s58, s3, 163840
    v_mfma_f32_16x16x32_bf16 v[124:127], a[52:55], a[92:95], v[124:127]
    ds_read_b128 a[116:119], v137 offset:49152
    s_add_u32 s59, s58, 81920
    v_mfma_f32_16x16x32_bf16 v[48:51], a[56:59], a[64:67], v[48:51]
    buffer_load_dwordx4 v143, s[20:23], s88 offen offset:3072 lds
    s_bfe_u32 s66, s69, 0x40000
    s_lshl_b32 s66, s66, 7
    v_mfma_f32_16x16x32_bf16 v[48:51], a[60:63], a[68:71], v[48:51]
    ds_read_b128 a[120:123], v136 offset:51200
    s_add_u32 s89, s84, s66
    v_mfma_f32_16x16x32_bf16 v[52:55], a[56:59], a[72:75], v[52:55]
    ds_read_b128 a[124:127], v137 offset:51200
    s_add_u32 m0, s80, 24576
    v_mfma_f32_16x16x32_bf16 v[52:55], a[60:63], a[76:79], v[52:55]
    buffer_load_dwordx4 v144, s[8:11], s89 offen offset:0 lds
    v_mfma_f32_16x16x32_bf16 v[56:59], a[56:59], a[80:83], v[56:59]
    s_bfe_u32 s3, s70, 0x40018
    s_lshl_b32 s46, s3, 13
    v_mfma_f32_16x16x32_bf16 v[56:59], a[60:63], a[84:87], v[56:59]
    s_mul_i32 s60, s3, 163840
    s_add_u32 s61, s60, 81920
    v_mfma_f32_16x16x32_bf16 v[60:63], a[56:59], a[88:91], v[60:63]
    buffer_load_dwordx4 v145, s[8:11], s89 offen offset:1024 lds
    v_mfma_f32_16x16x32_bf16 v[60:63], a[60:63], a[92:95], v[60:63]
    s_bfe_u32 s3, s70, 0x4001c
    s_lshl_b32 s47, s3, 13
    s_waitcnt vmcnt(28) lgkmcnt(0)
    s_barrier
    v_mfma_f32_16x16x32_bf16 v[64:67], a[0:3], a[96:99], v[64:67]
    ds_read_b64_tr_b16 a[32:33], v132 offset:0
    s_bfe_u32 s88, s69, 0x40000
    v_mfma_f32_16x16x32_bf16 v[64:67], a[4:7], a[100:103], v[64:67]
    ds_read_b64_tr_b16 a[34:35], v132 offset:1024
    s_lshl_b32 s88, s88, 19
    v_mfma_f32_16x16x32_bf16 v[68:71], a[0:3], a[104:107], v[68:71]
    ds_read_b64_tr_b16 a[36:37], v132 offset:8192
    s_add_u32 m0, s79, 49152
    v_mfma_f32_16x16x32_bf16 v[68:71], a[4:7], a[108:111], v[68:71]
    buffer_load_dwordx4 v140, s[20:23], s88 offen offset:0 lds
    v_mfma_f32_16x16x32_bf16 v[72:75], a[0:3], a[112:115], v[72:75]
    ds_read_b64_tr_b16 a[38:39], v132 offset:9216
    s_mul_i32 s62, s3, 163840
    v_mfma_f32_16x16x32_bf16 v[72:75], a[4:7], a[116:119], v[72:75]
    ds_read_b64_tr_b16 a[40:41], v133 offset:0
    s_add_u32 s63, s62, 81920
    v_mfma_f32_16x16x32_bf16 v[76:79], a[0:3], a[120:123], v[76:79]
    ds_read_b64_tr_b16 a[42:43], v133 offset:1024
    s_lshl_b32 s3, s77, 12
    v_mfma_f32_16x16x32_bf16 v[76:79], a[4:7], a[124:127], v[76:79]
    ds_read_b64_tr_b16 a[44:45], v133 offset:8192
    s_add_u32 s3, s3, 147456
    v_mfma_f32_16x16x32_bf16 v[0:3], a[8:11], a[96:99], v[0:3]
    buffer_load_dwordx4 v141, s[20:23], s88 offen offset:1024 lds
    v_mfma_f32_16x16x32_bf16 v[0:3], a[12:15], a[100:103], v[0:3]
    ds_read_b64_tr_b16 a[46:47], v133 offset:9216
    v_add_u32 v251, s3, v232
    v_mfma_f32_16x16x32_bf16 v[4:7], a[8:11], a[104:107], v[4:7]
    ds_read_b64_tr_b16 a[48:49], v134 offset:0
    s_lshl_b32 s3, s75, 7
    v_mfma_f32_16x16x32_bf16 v[4:7], a[12:15], a[108:111], v[4:7]
    ds_read_b64_tr_b16 a[50:51], v134 offset:1024
    s_lshl_b32 s4, s77, 6
    v_mfma_f32_16x16x32_bf16 v[8:11], a[8:11], a[112:115], v[8:11]
    ds_read_b64_tr_b16 a[52:53], v134 offset:8192
    s_add_u32 s3, s3, s4
    v_mfma_f32_16x16x32_bf16 v[8:11], a[12:15], a[116:119], v[8:11]
    buffer_load_dwordx4 v142, s[20:23], s88 offen offset:2048 lds
    v_mfma_f32_16x16x32_bf16 v[12:15], a[8:11], a[120:123], v[12:15]
    ds_read_b64_tr_b16 a[54:55], v134 offset:9216
    s_lshl_b32 s4, s74, 4
    v_mfma_f32_16x16x32_bf16 v[12:15], a[12:15], a[124:127], v[12:15]
    ds_read_b64_tr_b16 a[56:57], v135 offset:0
    s_add_u32 s3, s3, s4
    v_mfma_f32_16x16x32_bf16 v[80:83], a[16:19], a[96:99], v[80:83]
    ds_read_b64_tr_b16 a[58:59], v135 offset:1024
    s_mul_i32 s3, s3, 2560
    v_mfma_f32_16x16x32_bf16 v[80:83], a[20:23], a[100:103], v[80:83]
    ds_read_b64_tr_b16 a[60:61], v135 offset:8192
    s_mul_i32 s4, s73, 1280
    v_mfma_f32_16x16x32_bf16 v[84:87], a[16:19], a[104:107], v[84:87]
    ds_read_b64_tr_b16 a[62:63], v135 offset:9216
    s_add_u32 s3, s3, s4
    v_mfma_f32_16x16x32_bf16 v[84:87], a[20:23], a[108:111], v[84:87]
    buffer_load_dwordx4 v143, s[20:23], s88 offen offset:3072 lds
    v_mfma_f32_16x16x32_bf16 v[88:91], a[16:19], a[112:115], v[88:91]
    ds_read_b128 a[64:67], v138 offset:0
    s_mul_i32 s4, s76, 320
    v_mfma_f32_16x16x32_bf16 v[88:91], a[20:23], a[116:119], v[88:91]
    ds_read_b128 a[68:71], v139 offset:0
    s_add_u32 s3, s3, s4
    v_mfma_f32_16x16x32_bf16 v[92:95], a[16:19], a[120:123], v[92:95]
    ds_read_b128 a[72:75], v138 offset:2048
    s_add_u32 s89, s85, s66
    v_mfma_f32_16x16x32_bf16 v[92:95], a[20:23], a[124:127], v[92:95]
    ds_read_b128 a[76:79], v139 offset:2048
    s_add_u32 m0, s80, 49152
    v_mfma_f32_16x16x32_bf16 v[16:19], a[24:27], a[96:99], v[16:19]
    buffer_load_dwordx4 v144, s[8:11], s89 offen offset:0 lds
    v_mfma_f32_16x16x32_bf16 v[16:19], a[28:31], a[100:103], v[16:19]
    s_bfe_u32 s4, s6, 0x30010
    s_lshl_b32 s4, s4, 1
    v_mfma_f32_16x16x32_bf16 v[20:23], a[24:27], a[104:107], v[20:23]
    s_add_u32 s4, s4, s78
    s_lshl_b32 s4, s4, 5
    v_mfma_f32_16x16x32_bf16 v[20:23], a[28:31], a[108:111], v[20:23]
    s_add_u32 s97, s3, s4
    s_and_b32 s4, s6, 7
    v_mfma_f32_16x16x32_bf16 v[24:27], a[24:27], a[112:115], v[24:27]
    s_add_u32 s4, s4, s78
    s_lshl_b32 s4, s4, 6
    v_mfma_f32_16x16x32_bf16 v[24:27], a[28:31], a[116:119], v[24:27]
    buffer_load_dwordx4 v145, s[8:11], s89 offen offset:1024 lds
    v_mfma_f32_16x16x32_bf16 v[28:31], a[24:27], a[120:123], v[28:31]
    s_add_u32 s73, s3, s4
    s_mul_i32 s4, s5, 81920
    v_mfma_f32_16x16x32_bf16 v[28:31], a[28:31], a[124:127], v[28:31]
    s_sub_u32 s4, 40960, s4
    s_add_u32 s75, s73, s4
    s_waitcnt vmcnt(28) lgkmcnt(0)
    s_barrier
    v_mfma_f32_16x16x32_bf16 v[96:99], a[32:35], a[96:99], v[96:99]
    ds_read_b64_tr_b16 a[0:1], v132 offset:24576
    s_mov_b32 s99, 0x3e0293ee
    v_mfma_f32_16x16x32_bf16 v[96:99], a[36:39], a[100:103], v[96:99]
    ds_read_b64_tr_b16 a[2:3], v132 offset:25600
    s_add_u32 s88, s88, 128
    v_mfma_f32_16x16x32_bf16 v[100:103], a[32:35], a[104:107], v[100:103]
    ds_read_b64_tr_b16 a[4:5], v132 offset:32768
    s_add_u32 m0, s79, 73728
    v_mfma_f32_16x16x32_bf16 v[100:103], a[36:39], a[108:111], v[100:103]
    buffer_load_dwordx4 v140, s[20:23], s88 offen offset:0 lds
    v_mfma_f32_16x16x32_bf16 v[104:107], a[32:35], a[112:115], v[104:107]
    ds_read_b64_tr_b16 a[6:7], v132 offset:33792
    v_add_u32 v228, s82, v232
    v_mfma_f32_16x16x32_bf16 v[104:107], a[36:39], a[116:119], v[104:107]
    ds_read_b64_tr_b16 a[8:9], v133 offset:24576
    v_cmp_eq_u64 vcc, 0, v[230:231]
    v_mfma_f32_16x16x32_bf16 v[108:111], a[32:35], a[120:123], v[108:111]
    ds_read_b64_tr_b16 a[10:11], v133 offset:25600
    s_nop 0
    v_mfma_f32_16x16x32_bf16 v[108:111], a[36:39], a[124:127], v[108:111]
    ds_read_b64_tr_b16 a[12:13], v133 offset:32768
    s_nop 0
    v_mfma_f32_16x16x32_bf16 v[32:35], a[40:43], a[96:99], v[32:35]
    buffer_load_dwordx4 v141, s[20:23], s88 offen offset:1024 lds
    v_mfma_f32_16x16x32_bf16 v[32:35], a[44:47], a[100:103], v[32:35]
    ds_read_b64_tr_b16 a[14:15], v133 offset:33792
    s_cbranch_vccnz L_nslow
L_nback:
    v_mfma_f32_16x16x32_bf16 v[36:39], a[40:43], a[104:107], v[36:39]
    ds_read_b64_tr_b16 a[16:17], v134 offset:24576
    v_bfe_u32 v255, v232, 1, 6
    v_mfma_f32_16x16x32_bf16 v[36:39], a[44:47], a[108:111], v[36:39]
    ds_read_b64_tr_b16 a[18:19], v134 offset:25600
    v_lshrrev_b64 v[224:225], v255, v[230:231]
    v_mfma_f32_16x16x32_bf16 v[40:43], a[40:43], a[112:115], v[40:43]
    ds_read_b64_tr_b16 a[20:21], v134 offset:32768
    v_and_b32 v224, 0xff, v224
    v_mfma_f32_16x16x32_bf16 v[40:43], a[44:47], a[116:119], v[40:43]
    buffer_load_dwordx4 v142, s[20:23], s88 offen offset:2048 lds
    v_mfma_f32_16x16x32_bf16 v[44:47], a[40:43], a[120:123], v[44:47]
    ds_read_b64_tr_b16 a[22:23], v134 offset:33792
    v_mul_u32_u24 v224, 0x1001, v224
    v_mfma_f32_16x16x32_bf16 v[44:47], a[44:47], a[124:127], v[44:47]
    ds_read_b64_tr_b16 a[24:25], v135 offset:24576
    v_lshlrev_b32 v225, 14, v224
    v_mfma_f32_16x16x32_bf16 v[112:115], a[48:51], a[96:99], v[112:115]
    ds_read_b64_tr_b16 a[26:27], v135 offset:25600
    v_lshlrev_b32 v224, 12, v224
    v_mfma_f32_16x16x32_bf16 v[112:115], a[52:55], a[100:103], v[112:115]
    ds_read_b64_tr_b16 a[28:29], v135 offset:32768
L_pad2:
    s_cbranch_execz L_main
    v_and_b32 v224, 0xc000c000, v224
    v_mfma_f32_16x16x32_bf16 v[116:119], a[48:51], a[104:107], v[116:119]
    ds_read_b64_tr_b16 a[30:31], v135 offset:33792
    v_and_b32 v225, 0xc000c000, v225
    v_mfma_f32_16x16x32_bf16 v[116:119], a[52:55], a[108:111], v[116:119]
    buffer_load_dwordx4 v143, s[20:23], s88 offen offset:3072 lds
    v_mfma_f32_16x16x32_bf16 v[120:123], a[48:51], a[112:115], v[120:123]
    ds_read_b128 a[80:83], v138 offset:24576
    s_bfe_u32 s66, s69, 0x40004
    v_mfma_f32_16x16x32_bf16 v[120:123], a[52:55], a[116:119], v[120:123]
    ds_read_b128 a[84:87], v139 offset:24576
    s_lshl_b32 s66, s66, 7
    v_mfma_f32_16x16x32_bf16 v[124:127], a[48:51], a[120:123], v[124:127]
    ds_read_b128 a[88:91], v138 offset:26624
    s_add_u32 s89, s84, s66
    v_mfma_f32_16x16x32_bf16 v[124:127], a[52:55], a[124:127], v[124:127]
    ds_read_b128 a[92:95], v139 offset:26624
    s_add_u32 m0, s80, 73728
    v_mfma_f32_16x16x32_bf16 v[48:51], a[56:59], a[96:99], v[48:51]
    buffer_load_dwordx4 v144, s[8:11], s89 offen offset:0 lds
    v_mfma_f32_16x16x32_bf16 v[48:51], a[60:63], a[100:103], v[48:51]
    v_and_b32 v255, 48, v232
    v_lshrrev_b64 v[230:231], v255, v[230:231]
    v_mfma_f32_16x16x32_bf16 v[52:55], a[56:59], a[104:107], v[52:55]
    v_lshlrev_b32 v230, 16, v230
    v_mfma_f32_16x16x32_bf16 v[52:55], a[60:63], a[108:111], v[52:55]
    v_mfma_f32_16x16x32_bf16 v[56:59], a[56:59], a[112:115], v[56:59]
    v_mfma_f32_16x16x32_bf16 v[56:59], a[60:63], a[116:119], v[56:59]
    buffer_load_dwordx4 v145, s[8:11], s89 offen offset:1024 lds
    v_mfma_f32_16x16x32_bf16 v[60:63], a[56:59], a[120:123], v[60:63]
    v_mfma_f32_16x16x32_bf16 v[60:63], a[60:63], a[124:127], v[60:63]
    s_waitcnt vmcnt(18) lgkmcnt(0)
    s_barrier
    v_mfma_f32_16x16x32_bf16 v[64:67], a[0:3], a[64:67], v[64:67]
    ds_read_b64_tr_b16 a[32:33], v132 offset:49152
    s_bfe_u32 s88, s69, 0x40004
    v_mfma_f32_16x16x32_bf16 v[64:67], a[4:7], a[68:71], v[64:67]
    ds_read_b64_tr_b16 a[34:35], v132 offset:50176
    ds_read_b64_tr_b16 a[36:37], v132 offset:57344
    s_lshl_b32 s88, s88, 19
    v_mfma_f32_16x16x32_bf16 v[68:71], a[0:3], a[72:75], v[68:71]
    ds_read_b64_tr_b16 a[38:39], v132 offset:58368
    s_add_u32 m0, s79, 98304
    v_mfma_f32_16x16x32_bf16 v[68:71], a[4:7], a[76:79], v[68:71]
    buffer_load_dwordx4 v140, s[20:23], s88 offen offset:0 lds
    v_mfma_f32_16x16x32_bf16 v[72:75], a[0:3], a[80:83], v[72:75]
    ds_read_b64_tr_b16 a[40:41], v133 offset:49152
    v_mfma_f32_16x16x32_bf16 v[72:75], a[4:7], a[84:87], v[72:75]
    ds_read_b64_tr_b16 a[42:43], v133 offset:50176
    v_mfma_f32_16x16x32_bf16 v[76:79], a[0:3], a[88:91], v[76:79]
    ds_read_b64_tr_b16 a[44:45], v133 offset:57344
    ds_read_b64_tr_b16 a[46:47], v133 offset:58368
    v_mfma_f32_16x16x32_bf16 v[76:79], a[4:7], a[92:95], v[76:79]
    ds_read_b64_tr_b16 a[48:49], v134 offset:49152
    v_mfma_f32_16x16x32_bf16 v[0:3], a[8:11], a[64:67], v[0:3]
    buffer_load_dwordx4 v141, s[20:23], s88 offen offset:1024 lds
    v_mfma_f32_16x16x32_bf16 v[0:3], a[12:15], a[68:71], v[0:3]
    ds_read_b64_tr_b16 a[50:51], v134 offset:50176
    v_mfma_f32_16x16x32_bf16 v[4:7], a[8:11], a[72:75], v[4:7]
    ds_read_b64_tr_b16 a[52:53], v134 offset:57344
    v_mfma_f32_16x16x32_bf16 v[4:7], a[12:15], a[76:79], v[4:7]
    ds_read_b64_tr_b16 a[54:55], v134 offset:58368
    ds_read_b64_tr_b16 a[56:57], v135 offset:49152
    v_mfma_f32_16x16x32_bf16 v[8:11], a[8:11], a[80:83], v[8:11]
    ds_read_b64_tr_b16 a[58:59], v135 offset:50176
    v_mfma_f32_16x16x32_bf16 v[8:11], a[12:15], a[84:87], v[8:11]
    buffer_load_dwordx4 v142, s[20:23], s88 offen offset:2048 lds
    v_mfma_f32_16x16x32_bf16 v[12:15], a[8:11], a[88:91], v[12:15]
    ds_read_b64_tr_b16 a[60:61], v135 offset:57344
    v_mfma_f32_16x16x32_bf16 v[12:15], a[12:15], a[92:95], v[12:15]
    ds_read_b64_tr_b16 a[62:63], v135 offset:58368
    ds_read_b128 a[96:99], v138 offset:49152
    v_mfma_f32_16x16x32_bf16 v[80:83], a[16:19], a[64:67], v[80:83]
    ds_read_b128 a[100:103], v139 offset:49152
    v_mfma_f32_16x16x32_bf16 v[80:83], a[20:23], a[68:71], v[80:83]
    ds_read_b128 a[104:107], v138 offset:51200
    v_mfma_f32_16x16x32_bf16 v[84:87], a[16:19], a[72:75], v[84:87]
    ds_read_b128 a[108:111], v139 offset:51200
    v_mfma_f32_16x16x32_bf16 v[84:87], a[20:23], a[76:79], v[84:87]
    buffer_load_dwordx4 v143, s[20:23], s88 offen offset:3072 lds
    v_mfma_f32_16x16x32_bf16 v[88:91], a[16:19], a[80:83], v[88:91]
    ds_read_b64 a[224:225], v150
    ds_read_b64 a[226:227], v151
    v_mfma_f32_16x16x32_bf16 v[88:91], a[20:23], a[84:87], v[88:91]
    ds_read_b64 a[228:229], v152
    v_mfma_f32_16x16x32_bf16 v[92:95], a[16:19], a[88:91], v[92:95]
    ds_read_b64 a[230:231], v153
    s_add_u32 s89, s85, s66
    v_mfma_f32_16x16x32_bf16 v[92:95], a[20:23], a[92:95], v[92:95]
    ds_read_b64 a[232:233], v154
    s_add_u32 m0, s80, 98304
    v_mfma_f32_16x16x32_bf16 v[16:19], a[24:27], a[64:67], v[16:19]
    buffer_load_dwordx4 v144, s[8:11], s89 offen offset:0 lds
    v_mfma_f32_16x16x32_bf16 v[16:19], a[28:31], a[68:71], v[16:19]
    ds_read_b64 a[234:235], v155
    ds_read_b64 a[236:237], v156
    v_mfma_f32_16x16x32_bf16 v[20:23], a[24:27], a[72:75], v[20:23]
    ds_read_b64 a[238:239], v157
    v_mfma_f32_16x16x32_bf16 v[20:23], a[28:31], a[76:79], v[20:23]
    v_mfma_f32_16x16x32_bf16 v[24:27], a[24:27], a[80:83], v[24:27]
    v_mfma_f32_16x16x32_bf16 v[24:27], a[28:31], a[84:87], v[24:27]
    buffer_load_dwordx4 v145, s[8:11], s89 offen offset:1024 lds
    v_mfma_f32_16x16x32_bf16 v[28:31], a[24:27], a[88:91], v[28:31]
    v_mfma_f32_16x16x32_bf16 v[28:31], a[28:31], a[92:95], v[28:31]
    s_waitcnt vmcnt(28) lgkmcnt(0)
    s_barrier
    v_mfma_f32_16x16x32_bf16 v[96:99], a[32:35], a[64:67], v[96:99]
    ds_read_b64_tr_b16 a[0:1], v128 offset:0
    s_add_u32 s90, s87, 4096
    v_mfma_f32_16x16x32_bf16 v[96:99], a[36:39], a[68:71], v[96:99]
    ds_read_b64_tr_b16 a[2:3], v128 offset:1024
    s_mov_b32 m0, s82
    v_mfma_f32_16x16x32_bf16 v[100:103], a[32:35], a[72:75], v[100:103]
    buffer_load_dwordx4 v146, s[12:15], s90 offen offset:0 lds
    v_mfma_f32_16x16x32_bf16 v[100:103], a[36:39], a[76:79], v[100:103]
    ds_read_b64_tr_b16 a[4:5], v128 offset:8192
    v_mfma_f32_16x16x32_bf16 v[104:107], a[32:35], a[80:83], v[104:107]
    ds_read_b64_tr_b16 a[6:7], v128 offset:9216
    v_mfma_f32_16x16x32_bf16 v[104:107], a[36:39], a[84:87], v[104:107]
    ds_read_b64_tr_b16 a[8:9], v129 offset:0
    v_mfma_f32_16x16x32_bf16 v[108:111], a[32:35], a[88:91], v[108:111]
    buffer_load_dwordx4 v147, s[12:15], s90 offen offset:1024 lds
    v_mfma_f32_16x16x32_bf16 v[108:111], a[36:39], a[92:95], v[108:111]
    ds_read_b64_tr_b16 a[10:11], v129 offset:1024
    v_mfma_f32_16x16x32_bf16 v[32:35], a[40:43], a[64:67], v[32:35]
    ds_read_b64_tr_b16 a[12:13], v129 offset:8192
    v_mfma_f32_16x16x32_bf16 v[32:35], a[44:47], a[68:71], v[32:35]
    ds_read_b64_tr_b16 a[14:15], v129 offset:9216
    v_mfma_f32_16x16x32_bf16 v[36:39], a[40:43], a[72:75], v[36:39]
    buffer_load_dwordx4 v148, s[12:15], s90 offen offset:2048 lds
    v_mfma_f32_16x16x32_bf16 v[36:39], a[44:47], a[76:79], v[36:39]
    ds_read_b64_tr_b16 a[16:17], v130 offset:0
    v_mfma_f32_16x16x32_bf16 v[40:43], a[40:43], a[80:83], v[40:43]
    ds_read_b64_tr_b16 a[18:19], v130 offset:1024
    v_mfma_f32_16x16x32_bf16 v[40:43], a[44:47], a[84:87], v[40:43]
    ds_read_b64_tr_b16 a[20:21], v130 offset:8192
    v_mfma_f32_16x16x32_bf16 v[44:47], a[40:43], a[88:91], v[44:47]
    buffer_load_dwordx4 v149, s[12:15], s90 offen offset:3072 lds
    v_mfma_f32_16x16x32_bf16 v[44:47], a[44:47], a[92:95], v[44:47]
    ds_read_b64_tr_b16 a[22:23], v130 offset:9216
    v_mfma_f32_16x16x32_bf16 v[112:115], a[48:51], a[64:67], v[112:115]
    ds_read_b64_tr_b16 a[24:25], v131 offset:0
    s_add_u32 s88, s88, 128
    v_mfma_f32_16x16x32_bf16 v[112:115], a[52:55], a[68:71], v[112:115]
    ds_read_b64_tr_b16 a[26:27], v131 offset:1024
    s_add_u32 m0, s79, 122880
    v_mfma_f32_16x16x32_bf16 v[116:119], a[48:51], a[72:75], v[116:119]
    buffer_load_dwordx4 v140, s[20:23], s88 offen offset:0 lds
    v_mfma_f32_16x16x32_bf16 v[116:119], a[52:55], a[76:79], v[116:119]
    ds_read_b64_tr_b16 a[28:29], v131 offset:8192
    v_mfma_f32_16x16x32_bf16 v[120:123], a[48:51], a[80:83], v[120:123]
    ds_read_b64_tr_b16 a[30:31], v131 offset:9216
    v_mfma_f32_16x16x32_bf16 v[120:123], a[52:55], a[84:87], v[120:123]
    ds_read_b128 a[112:115], v136 offset:0
    v_mfma_f32_16x16x32_bf16 v[124:127], a[48:51], a[88:91], v[124:127]
    buffer_load_dwordx4 v141, s[20:23], s88 offen offset:1024 lds
    v_mfma_f32_16x16x32_bf16 v[124:127], a[52:55], a[92:95], v[124:127]
    ds_read_b128 a[116:119], v137 offset:0
    v_mfma_f32_16x16x32_bf16 v[48:51], a[56:59], a[64:67], v[48:51]
    ds_read_b128 a[120:123], v136 offset:2048
    v_mfma_f32_16x16x32_bf16 v[48:51], a[60:63], a[68:71], v[48:51]
    ds_read_b128 a[124:127], v137 offset:2048
    v_mfma_f32_16x16x32_bf16 v[52:55], a[56:59], a[72:75], v[52:55]
    buffer_load_dwordx4 v142, s[20:23], s88 offen offset:2048 lds
    v_mfma_f32_16x16x32_bf16 v[52:55], a[60:63], a[76:79], v[52:55]
    v_mfma_f32_16x16x32_bf16 v[56:59], a[56:59], a[80:83], v[56:59]
    v_mfma_f32_16x16x32_bf16 v[56:59], a[60:63], a[84:87], v[56:59]
    v_mfma_f32_16x16x32_bf16 v[60:63], a[56:59], a[88:91], v[60:63]
    buffer_load_dwordx4 v143, s[20:23], s88 offen offset:3072 lds
    v_mfma_f32_16x16x32_bf16 v[60:63], a[60:63], a[92:95], v[60:63]
    s_waitcnt vmcnt(26) lgkmcnt(0)
    s_barrier
    v_mfma_f32_16x16x32_bf16 v[64:67], a[0:3], a[96:99], v[64:67]
    ds_read_b64_tr_b16 a[32:33], v128 offset:24576
    v_mfma_f32_16x16x32_bf16 v[64:67], a[4:7], a[100:103], v[64:67]
    ds_read_b64_tr_b16 a[34:35], v128 offset:25600
    v_mfma_f32_16x16x32_bf16 v[68:71], a[0:3], a[104:107], v[68:71]
    ds_read_b64_tr_b16 a[36:37], v128 offset:32768
    v_mfma_f32_16x16x32_bf16 v[68:71], a[4:7], a[108:111], v[68:71]
    ds_read_b64_tr_b16 a[38:39], v128 offset:33792
    s_add_u32 m0, s79, 0
    v_mfma_f32_16x16x32_bf16 v[72:75], a[0:3], a[112:115], v[72:75]
    buffer_load_dwordx4 v234, s[16:19], s40 offen offset:0 lds
    v_mfma_f32_16x16x32_bf16 v[72:75], a[4:7], a[116:119], v[72:75]
    ds_read_b64_tr_b16 a[40:41], v129 offset:24576
    v_mfma_f32_16x16x32_bf16 v[76:79], a[0:3], a[120:123], v[76:79]
    ds_read_b64_tr_b16 a[42:43], v129 offset:25600
    v_mfma_f32_16x16x32_bf16 v[76:79], a[4:7], a[124:127], v[76:79]
    ds_read_b64_tr_b16 a[44:45], v129 offset:32768
    v_mfma_f32_16x16x32_bf16 v[0:3], a[8:11], a[96:99], v[0:3]
    ds_read_b64_tr_b16 a[46:47], v129 offset:33792
    v_mfma_f32_16x16x32_bf16 v[0:3], a[12:15], a[100:103], v[0:3]
    ds_read_b64_tr_b16 a[48:49], v130 offset:24576
    v_mfma_f32_16x16x32_bf16 v[4:7], a[8:11], a[104:107], v[4:7]
    ds_read_b64_tr_b16 a[50:51], v130 offset:25600
    v_mfma_f32_16x16x32_bf16 v[4:7], a[12:15], a[108:111], v[4:7]
    ds_read_b64_tr_b16 a[52:53], v130 offset:32768
    v_mfma_f32_16x16x32_bf16 v[8:11], a[8:11], a[112:115], v[8:11]
    buffer_load_dwordx4 v235, s[16:19], s40 offen offset:1024 lds
    v_mfma_f32_16x16x32_bf16 v[8:11], a[12:15], a[116:119], v[8:11]
    ds_read_b64_tr_b16 a[54:55], v130 offset:33792
    v_mfma_f32_16x16x32_bf16 v[12:15], a[8:11], a[120:123], v[12:15]
    ds_read_b64_tr_b16 a[56:57], v131 offset:24576
    v_mfma_f32_16x16x32_bf16 v[12:15], a[12:15], a[124:127], v[12:15]
    ds_read_b64_tr_b16 a[58:59], v131 offset:25600
    v_mfma_f32_16x16x32_bf16 v[80:83], a[16:19], a[96:99], v[80:83]
    ds_read_b64_tr_b16 a[60:61], v131 offset:32768
    v_mfma_f32_16x16x32_bf16 v[80:83], a[20:23], a[100:103], v[80:83]
    ds_read_b64_tr_b16 a[62:63], v131 offset:33792
    v_mfma_f32_16x16x32_bf16 v[84:87], a[16:19], a[104:107], v[84:87]
    ds_read_b128 a[64:67], v136 offset:24576
    v_mfma_f32_16x16x32_bf16 v[84:87], a[20:23], a[108:111], v[84:87]
    ds_read_b128 a[68:71], v137 offset:24576
    v_mfma_f32_16x16x32_bf16 v[88:91], a[16:19], a[112:115], v[88:91]
    buffer_load_dwordx4 v236, s[16:19], s40 offen offset:2048 lds
    v_mfma_f32_16x16x32_bf16 v[88:91], a[20:23], a[116:119], v[88:91]
    ds_read_b128 a[72:75], v136 offset:26624
    v_mfma_f32_16x16x32_bf16 v[92:95], a[16:19], a[120:123], v[92:95]
    ds_read_b128 a[76:79], v137 offset:26624
    v_mfma_f32_16x16x32_bf16 v[92:95], a[20:23], a[124:127], v[92:95]
    v_mfma_f32_16x16x32_bf16 v[16:19], a[24:27], a[96:99], v[16:19]
    v_mfma_f32_16x16x32_bf16 v[16:19], a[28:31], a[100:103], v[16:19]
    v_mfma_f32_16x16x32_bf16 v[20:23], a[24:27], a[104:107], v[20:23]
    v_mfma_f32_16x16x32_bf16 v[20:23], a[28:31], a[108:111], v[20:23]
    v_mfma_f32_16x16x32_bf16 v[24:27], a[24:27], a[112:115], v[24:27]
    buffer_load_dwordx4 v237, s[16:19], s40 offen offset:3072 lds
    v_mfma_f32_16x16x32_bf16 v[24:27], a[28:31], a[116:119], v[24:27]
    v_mfma_f32_16x16x32_bf16 v[28:31], a[24:27], a[120:123], v[28:31]
    v_mfma_f32_16x16x32_bf16 v[28:31], a[28:31], a[124:127], v[28:31]
    s_waitcnt vmcnt(24) lgkmcnt(0)
    s_barrier
    v_mfma_f32_16x16x32_bf16 v[96:99], a[32:35], a[96:99], v[96:99]
    ds_read_b64_tr_b16 a[0:1], v128 offset:49152
    v_mfma_f32_16x16x32_bf16 v[96:99], a[36:39], a[100:103], v[96:99]
    ds_read_b64_tr_b16 a[2:3], v128 offset:50176
    v_mfma_f32_16x16x32_bf16 v[100:103], a[32:35], a[104:107], v[100:103]
    ds_read_b64_tr_b16 a[4:5], v128 offset:57344
    v_mfma_f32_16x16x32_bf16 v[100:103], a[36:39], a[108:111], v[100:103]
    ds_read_b64_tr_b16 a[6:7], v128 offset:58368
    s_add_u32 m0, s81, 0
    v_mfma_f32_16x16x32_bf16 v[104:107], a[32:35], a[112:115], v[104:107]
    buffer_load_dwordx4 v238, s[24:27], s48 offen offset:0 lds
    v_mfma_f32_16x16x32_bf16 v[104:107], a[36:39], a[116:119], v[104:107]
    ds_read_b64_tr_b16 a[8:9], v129 offset:49152
    v_mfma_f32_16x16x32_bf16 v[108:111], a[32:35], a[120:123], v[108:111]
    ds_read_b64_tr_b16 a[10:11], v129 offset:50176
    v_mfma_f32_16x16x32_bf16 v[108:111], a[36:39], a[124:127], v[108:111]
    ds_read_b64_tr_b16 a[12:13], v129 offset:57344
    v_mfma_f32_16x16x32_bf16 v[32:35], a[40:43], a[96:99], v[32:35]
    ds_read_b64_tr_b16 a[14:15], v129 offset:58368
    v_mfma_f32_16x16x32_bf16 v[32:35], a[44:47], a[100:103], v[32:35]
    ds_read_b64_tr_b16 a[16:17], v130 offset:49152
    v_mfma_f32_16x16x32_bf16 v[36:39], a[40:43], a[104:107], v[36:39]
    buffer_load_dwordx4 v239, s[24:27], s48 offen offset:1024 lds
    v_mfma_f32_16x16x32_bf16 v[36:39], a[44:47], a[108:111], v[36:39]
    ds_read_b64_tr_b16 a[18:19], v130 offset:50176
    v_mfma_f32_16x16x32_bf16 v[40:43], a[40:43], a[112:115], v[40:43]
    ds_read_b64_tr_b16 a[20:21], v130 offset:57344
    v_mfma_f32_16x16x32_bf16 v[40:43], a[44:47], a[116:119], v[40:43]
    ds_read_b64_tr_b16 a[22:23], v130 offset:58368
    v_mfma_f32_16x16x32_bf16 v[44:47], a[40:43], a[120:123], v[44:47]
    ds_read_b64_tr_b16 a[24:25], v131 offset:49152
    v_mfma_f32_16x16x32_bf16 v[44:47], a[44:47], a[124:127], v[44:47]
    ds_read_b64_tr_b16 a[26:27], v131 offset:50176
    v_mfma_f32_16x16x32_bf16 v[112:115], a[48:51], a[96:99], v[112:115]
    buffer_load_dwordx4 v240, s[24:27], s48 offen offset:2048 lds
    v_mfma_f32_16x16x32_bf16 v[112:115], a[52:55], a[100:103], v[112:115]
    ds_read_b64_tr_b16 a[28:29], v131 offset:57344
    v_mfma_f32_16x16x32_bf16 v[116:119], a[48:51], a[104:107], v[116:119]
    ds_read_b64_tr_b16 a[30:31], v131 offset:58368
    v_mfma_f32_16x16x32_bf16 v[116:119], a[52:55], a[108:111], v[116:119]
    ds_read_b128 a[80:83], v136 offset:49152
    v_mfma_f32_16x16x32_bf16 v[120:123], a[48:51], a[112:115], v[120:123]
    ds_read_b128 a[84:87], v137 offset:49152
    v_mfma_f32_16x16x32_bf16 v[120:123], a[52:55], a[116:119], v[120:123]
    ds_read_b128 a[88:91], v136 offset:51200
    v_mfma_f32_16x16x32_bf16 v[124:127], a[48:51], a[120:123], v[124:127]
    buffer_load_dwordx4 v241, s[24:27], s48 offen offset:3072 lds
    v_mfma_f32_16x16x32_bf16 v[124:127], a[52:55], a[124:127], v[124:127]
    ds_read_b128 a[92:95], v137 offset:51200
    v_mfma_f32_16x16x32_bf16 v[48:51], a[56:59], a[96:99], v[48:51]
    v_mfma_f32_16x16x32_bf16 v[48:51], a[60:63], a[100:103], v[48:51]
    v_mfma_f32_16x16x32_bf16 v[52:55], a[56:59], a[104:107], v[52:55]
    v_mfma_f32_16x16x32_bf16 v[52:55], a[60:63], a[108:111], v[52:55]
    s_add_u32 m0, s81, 4096
    v_mfma_f32_16x16x32_bf16 v[56:59], a[56:59], a[112:115], v[56:59]
    buffer_load_dwordx4 v242, s[24:27], s48 offen offset:0 lds
    v_mfma_f32_16x16x32_bf16 v[56:59], a[60:63], a[116:119], v[56:59]
    v_mfma_f32_16x16x32_bf16 v[60:63], a[56:59], a[120:123], v[60:63]
    v_mfma_f32_16x16x32_bf16 v[60:63], a[60:63], a[124:127], v[60:63]
    s_waitcnt vmcnt(13) lgkmcnt(0)
    s_barrier
    v_mfma_f32_16x16x32_bf16 v[64:67], a[0:3], a[64:67], v[64:67]
    ds_read_b64_tr_b16 a[32:33], v132 offset:0
    v_mfma_f32_16x16x32_bf16 v[64:67], a[4:7], a[68:71], v[64:67]
    ds_read_b64_tr_b16 a[34:35], v132 offset:1024
    v_mfma_f32_16x16x32_bf16 v[68:71], a[0:3], a[72:75], v[68:71]
    ds_read_b64_tr_b16 a[36:37], v132 offset:8192
    v_mfma_f32_16x16x32_bf16 v[68:71], a[4:7], a[76:79], v[68:71]
    ds_read_b64_tr_b16 a[38:39], v132 offset:9216
    ds_read_b64_tr_b16 a[40:41], v133 offset:0
    s_add_u32 m0, s79, 36736
    v_mfma_f32_16x16x32_bf16 v[72:75], a[0:3], a[80:83], v[72:75]
    buffer_load_dwordx4 v234, s[16:19], s40 offen offset:128 lds
    v_mfma_f32_16x16x32_bf16 v[72:75], a[4:7], a[84:87], v[72:75]
    ds_read_b64_tr_b16 a[42:43], v133 offset:1024
    v_mfma_f32_16x16x32_bf16 v[76:79], a[0:3], a[88:91], v[76:79]
    ds_read_b64_tr_b16 a[44:45], v133 offset:8192
    v_mfma_f32_16x16x32_bf16 v[76:79], a[4:7], a[92:95], v[76:79]
    ds_read_b64_tr_b16 a[46:47], v133 offset:9216
    v_mfma_f32_16x16x32_bf16 v[0:3], a[8:11], a[64:67], v[0:3]
    ds_read_b64_tr_b16 a[48:49], v134 offset:0
    v_mfma_f32_16x16x32_bf16 v[0:3], a[12:15], a[68:71], v[0:3]
    ds_read_b64_tr_b16 a[50:51], v134 offset:1024
    v_mfma_f32_16x16x32_bf16 v[4:7], a[8:11], a[72:75], v[4:7]
    ds_read_b64_tr_b16 a[52:53], v134 offset:8192
    ds_read_b64_tr_b16 a[54:55], v134 offset:9216
    v_mfma_f32_16x16x32_bf16 v[4:7], a[12:15], a[76:79], v[4:7]
    ds_read_b64_tr_b16 a[56:57], v135 offset:0
    v_mfma_f32_16x16x32_bf16 v[8:11], a[8:11], a[80:83], v[8:11]
    buffer_load_dwordx4 v235, s[16:19], s40 offen offset:1152 lds
    v_mfma_f32_16x16x32_bf16 v[8:11], a[12:15], a[84:87], v[8:11]
    ds_read_b64_tr_b16 a[58:59], v135 offset:1024
    v_mfma_f32_16x16x32_bf16 v[12:15], a[8:11], a[88:91], v[12:15]
    ds_read_b64_tr_b16 a[60:61], v135 offset:8192
    v_mfma_f32_16x16x32_bf16 v[12:15], a[12:15], a[92:95], v[12:15]
    ds_read_b64_tr_b16 a[62:63], v135 offset:9216
    v_mfma_f32_16x16x32_bf16 v[80:83], a[16:19], a[64:67], v[80:83]
    ds_read_b128 a[96:99], v138 offset:0
    v_mfma_f32_16x16x32_bf16 v[80:83], a[20:23], a[68:71], v[80:83]
    ds_read_b128 a[100:103], v139 offset:0
    ds_read_b128 a[104:107], v138 offset:2048
    v_mfma_f32_16x16x32_bf16 v[84:87], a[16:19], a[72:75], v[84:87]
    ds_read_b128 a[108:111], v139 offset:2048
    v_mfma_f32_16x16x32_bf16 v[84:87], a[20:23], a[76:79], v[84:87]
    ds_read_b64 a[240:241], v150
    v_mfma_f32_16x16x32_bf16 v[88:91], a[16:19], a[80:83], v[88:91]
    buffer_load_dwordx4 v236, s[16:19], s40 offen offset:2176 lds
    v_mfma_f32_16x16x32_bf16 v[88:91], a[20:23], a[84:87], v[88:91]
    ds_read_b64 a[242:243], v151
    v_mfma_f32_16x16x32_bf16 v[92:95], a[16:19], a[88:91], v[92:95]
    ds_read_b64 a[244:245], v152
    v_mfma_f32_16x16x32_bf16 v[92:95], a[20:23], a[92:95], v[92:95]
    ds_read_b64 a[246:247], v153
    v_mfma_f32_16x16x32_bf16 v[16:19], a[24:27], a[64:67], v[16:19]
    ds_read_b64 a[248:249], v154
    ds_read_b64 a[250:251], v155
    v_mfma_f32_16x16x32_bf16 v[16:19], a[28:31], a[68:71], v[16:19]
    ds_read_b64 a[252:253], v156
    v_mfma_f32_16x16x32_bf16 v[20:23], a[24:27], a[72:75], v[20:23]
    ds_read_b64 a[254:255], v157
    v_mfma_f32_16x16x32_bf16 v[20:23], a[28:31], a[76:79], v[20:23]
    v_mfma_f32_16x16x32_bf16 v[24:27], a[24:27], a[80:83], v[24:27]
    buffer_load_dwordx4 v237, s[16:19], s40 offen offset:3200 lds
    v_mfma_f32_16x16x32_bf16 v[24:27], a[28:31], a[84:87], v[24:27]
    v_mfma_f32_16x16x32_bf16 v[28:31], a[24:27], a[88:91], v[28:31]
    v_mfma_f32_16x16x32_bf16 v[28:31], a[28:31], a[92:95], v[28:31]
    s_waitcnt vmcnt(21) lgkmcnt(0)
    s_barrier
    v_mfma_f32_16x16x32_bf16 v[96:99], a[32:35], a[64:67], v[96:99]
    ds_read_b64_tr_b16 a[0:1], v132 offset:24576
    v_mfma_f32_16x16x32_bf16 v[96:99], a[36:39], a[68:71], v[96:99]
    ds_read_b64_tr_b16 a[2:3], v132 offset:25600
    v_mfma_f32_16x16x32_bf16 v[100:103], a[32:35], a[72:75], v[100:103]
    ds_read_b64_tr_b16 a[4:5], v132 offset:32768
    v_mfma_f32_16x16x32_bf16 v[100:103], a[36:39], a[76:79], v[100:103]
    ds_read_b64_tr_b16 a[6:7], v132 offset:33792
    s_add_u32 m0, s81, 36864
    v_mfma_f32_16x16x32_bf16 v[104:107], a[32:35], a[80:83], v[104:107]
    buffer_load_dwordx4 v238, s[24:27], s49 offen offset:0 lds
    v_mfma_f32_16x16x32_bf16 v[104:107], a[36:39], a[84:87], v[104:107]
    ds_read_b64_tr_b16 a[8:9], v133 offset:24576
    v_mfma_f32_16x16x32_bf16 v[108:111], a[32:35], a[88:91], v[108:111]
    ds_read_b64_tr_b16 a[10:11], v133 offset:25600
    v_mfma_f32_16x16x32_bf16 v[108:111], a[36:39], a[92:95], v[108:111]
    ds_read_b64_tr_b16 a[12:13], v133 offset:32768
    v_mfma_f32_16x16x32_bf16 v[32:35], a[40:43], a[64:67], v[32:35]
    ds_read_b64_tr_b16 a[14:15], v133 offset:33792
    v_mfma_f32_16x16x32_bf16 v[32:35], a[44:47], a[68:71], v[32:35]
    ds_read_b64_tr_b16 a[16:17], v134 offset:24576
    v_mfma_f32_16x16x32_bf16 v[36:39], a[40:43], a[72:75], v[36:39]
    buffer_load_dwordx4 v239, s[24:27], s49 offen offset:1024 lds
    v_mfma_f32_16x16x32_bf16 v[36:39], a[44:47], a[76:79], v[36:39]
    ds_read_b64_tr_b16 a[18:19], v134 offset:25600
    v_mfma_f32_16x16x32_bf16 v[40:43], a[40:43], a[80:83], v[40:43]
    ds_read_b64_tr_b16 a[20:21], v134 offset:32768
    v_mfma_f32_16x16x32_bf16 v[40:43], a[44:47], a[84:87], v[40:43]
    ds_read_b64_tr_b16 a[22:23], v134 offset:33792
    v_mfma_f32_16x16x32_bf16 v[44:47], a[40:43], a[88:91], v[44:47]
    ds_read_b64_tr_b16 a[24:25], v135 offset:24576
    v_mfma_f32_16x16x32_bf16 v[44:47], a[44:47], a[92:95], v[44:47]
    ds_read_b64_tr_b16 a[26:27], v135 offset:25600
    v_mfma_f32_16x16x32_bf16 v[112:115], a[48:51], a[64:67], v[112:115]
    buffer_load_dwordx4 v240, s[24:27], s49 offen offset:2048 lds
    v_mfma_f32_16x16x32_bf16 v[112:115], a[52:55], a[68:71], v[112:115]
    ds_read_b64_tr_b16 a[28:29], v135 offset:32768
    v_mfma_f32_16x16x32_bf16 v[116:119], a[48:51], a[72:75], v[116:119]
    ds_read_b64_tr_b16 a[30:31], v135 offset:33792
    v_mfma_f32_16x16x32_bf16 v[116:119], a[52:55], a[76:79], v[116:119]
    ds_read_b128 a[112:115], v138 offset:24576
    v_mfma_f32_16x16x32_bf16 v[120:123], a[48:51], a[80:83], v[120:123]
    ds_read_b128 a[116:119], v139 offset:24576
    v_mfma_f32_16x16x32_bf16 v[120:123], a[52:55], a[84:87], v[120:123]
    ds_read_b128 a[120:123], v138 offset:26624
    v_mfma_f32_16x16x32_bf16 v[124:127], a[48:51], a[88:91], v[124:127]
    buffer_load_dwordx4 v241, s[24:27], s49 offen offset:3072 lds
    v_mfma_f32_16x16x32_bf16 v[124:127], a[52:55], a[92:95], v[124:127]
    ds_read_b128 a[124:127], v139 offset:26624
    v_mfma_f32_16x16x32_bf16 v[48:51], a[56:59], a[64:67], v[48:51]
    v_mfma_f32_16x16x32_bf16 v[48:51], a[60:63], a[68:71], v[48:51]
    v_mfma_f32_16x16x32_bf16 v[52:55], a[56:59], a[72:75], v[52:55]
    v_mfma_f32_16x16x32_bf16 v[52:55], a[60:63], a[76:79], v[52:55]
    s_add_u32 m0, s81, 40960
    v_mfma_f32_16x16x32_bf16 v[56:59], a[56:59], a[80:83], v[56:59]
    buffer_load_dwordx4 v242, s[24:27], s49 offen offset:0 lds
    v_mfma_f32_16x16x32_bf16 v[56:59], a[60:63], a[84:87], v[56:59]
    v_mfma_f32_16x16x32_bf16 v[60:63], a[56:59], a[88:91], v[60:63]
    v_mfma_f32_16x16x32_bf16 v[60:63], a[60:63], a[92:95], v[60:63]
    s_waitcnt vmcnt(18) lgkmcnt(0)
    s_barrier
    v_mfma_f32_16x16x32_bf16 v[64:67], a[0:3], a[96:99], v[64:67]
    ds_read_b64_tr_b16 a[32:33], v132 offset:49152
    v_mfma_f32_16x16x32_bf16 v[64:67], a[4:7], a[100:103], v[64:67]
    ds_read_b64_tr_b16 a[34:35], v132 offset:50176
    v_mfma_f32_16x16x32_bf16 v[68:71], a[0:3], a[104:107], v[68:71]
    ds_read_b64_tr_b16 a[36:37], v132 offset:57344
    v_mfma_f32_16x16x32_bf16 v[68:71], a[4:7], a[108:111], v[68:71]
    ds_read_b64_tr_b16 a[38:39], v132 offset:58368
    s_add_u32 m0, s79, 73728
    v_mfma_f32_16x16x32_bf16 v[72:75], a[0:3], a[112:115], v[72:75]
    buffer_load_dwordx4 v234, s[16:19], s41 offen offset:0 lds
    v_mfma_f32_16x16x32_bf16 v[72:75], a[4:7], a[116:119], v[72:75]
    ds_read_b64_tr_b16 a[40:41], v133 offset:49152
    v_mfma_f32_16x16x32_bf16 v[76:79], a[0:3], a[120:123], v[76:79]
    ds_read_b64_tr_b16 a[42:43], v133 offset:50176
    v_mfma_f32_16x16x32_bf16 v[76:79], a[4:7], a[124:127], v[76:79]
    ds_read_b64_tr_b16 a[44:45], v133 offset:57344
    v_mfma_f32_16x16x32_bf16 v[0:3], a[8:11], a[96:99], v[0:3]
    ds_read_b64_tr_b16 a[46:47], v133 offset:58368
    v_mfma_f32_16x16x32_bf16 v[0:3], a[12:15], a[100:103], v[0:3]
    ds_read_b64_tr_b16 a[48:49], v134 offset:49152
    v_mfma_f32_16x16x32_bf16 v[4:7], a[8:11], a[104:107], v[4:7]
    ds_read_b64_tr_b16 a[50:51], v134 offset:50176
    v_mfma_f32_16x16x32_bf16 v[4:7], a[12:15], a[108:111], v[4:7]
    ds_read_b64_tr_b16 a[52:53], v134 offset:57344
    v_mfma_f32_16x16x32_bf16 v[8:11], a[8:11], a[112:115], v[8:11]
    buffer_load_dwordx4 v235, s[16:19], s41 offen offset:1024 lds
    v_mfma_f32_16x16x32_bf16 v[8:11], a[12:15], a[116:119], v[8:11]
    ds_read_b64_tr_b16 a[54:55], v134 offset:58368
    v_mfma_f32_16x16x32_bf16 v[12:15], a[8:11], a[120:123], v[12:15]
    ds_read_b64_tr_b16 a[56:57], v135 offset:49152
    v_mfma_f32_16x16x32_bf16 v[12:15], a[12:15], a[124:127], v[12:15]
    ds_read_b64_tr_b16 a[58:59], v135 offset:50176
    v_mfma_f32_16x16x32_bf16 v[80:83], a[16:19], a[96:99], v[80:83]
    ds_read_b64_tr_b16 a[60:61], v135 offset:57344
    v_mfma_f32_16x16x32_bf16 v[80:83], a[20:23], a[100:103], v[80:83]
    ds_read_b64_tr_b16 a[62:63], v135 offset:58368
    v_mfma_f32_16x16x32_bf16 v[84:87], a[16:19], a[104:107], v[84:87]
    v_mfma_f32_16x16x32_bf16 v[84:87], a[20:23], a[108:111], v[84:87]
    v_mfma_f32_16x16x32_bf16 v[88:91], a[16:19], a[112:115], v[88:91]
    buffer_load_dwordx4 v236, s[16:19], s41 offen offset:2048 lds
    v_mfma_f32_16x16x32_bf16 v[88:91], a[20:23], a[116:119], v[88:91]
    v_mfma_f32_16x16x32_bf16 v[92:95], a[16:19], a[120:123], v[92:95]
    v_mfma_f32_16x16x32_bf16 v[92:95], a[20:23], a[124:127], v[92:95]
    v_mfma_f32_16x16x32_bf16 v[16:19], a[24:27], a[96:99], v[16:19]
    v_mfma_f32_16x16x32_bf16 v[16:19], a[28:31], a[100:103], v[16:19]
    v_mfma_f32_16x16x32_bf16 v[20:23], a[24:27], a[104:107], v[20:23]
    v_mfma_f32_16x16x32_bf16 v[20:23], a[28:31], a[108:111], v[20:23]
    v_mfma_f32_16x16x32_bf16 v[24:27], a[24:27], a[112:115], v[24:27]
    buffer_load_dwordx4 v237, s[16:19], s41 offen offset:3072 lds
    v_mfma_f32_16x16x32_bf16 v[24:27], a[28:31], a[116:119], v[24:27]
    v_mfma_f32_16x16x32_bf16 v[28:31], a[24:27], a[120:123], v[28:31]
    v_mfma_f32_16x16x32_bf16 v[28:31], a[28:31], a[124:127], v[28:31]
    s_waitcnt vmcnt(13) lgkmcnt(0)
    s_barrier
    v_mfma_f32_16x16x32_bf16 v[96:99], a[32:35], a[96:99], v[96:99]
    ds_read_b128 a[128:131], v243 offset:0
    v_cvt_pk_bf16_f32 v64, v64, v65
    v_mfma_f32_16x16x32_bf16 v[96:99], a[36:39], a[100:103], v[96:99]
    ds_read_b128 a[132:135], v244 offset:0
    v_cvt_pk_bf16_f32 v65, v66, v67
    v_mfma_f32_16x16x32_bf16 v[100:103], a[32:35], a[104:107], v[100:103]
    ds_read_b128 a[136:139], v243 offset:2048
    ds_read_b128 a[140:143], v244 offset:2048
    v_cvt_pk_bf16_f32 v66, v0, v1
    v_mfma_f32_16x16x32_bf16 v[100:103], a[36:39], a[108:111], v[100:103]
    ds_read_b128 a[144:147], v243 offset:4096
    s_add_u32 m0, s81, 73728
    v_mfma_f32_16x16x32_bf16 v[104:107], a[32:35], a[112:115], v[104:107]
    buffer_load_dwordx4 v238, s[24:27], s50 offen offset:0 lds
    v_mfma_f32_16x16x32_bf16 v[104:107], a[36:39], a[116:119], v[104:107]
    ds_read_b128 a[148:151], v244 offset:4096
    v_cvt_pk_bf16_f32 v67, v2, v3
    v_mfma_f32_16x16x32_bf16 v[108:111], a[32:35], a[120:123], v[108:111]
    ds_read_b128 a[152:155], v243 offset:6144
    v_cvt_pk_bf16_f32 v80, v80, v81
    v_mfma_f32_16x16x32_bf16 v[108:111], a[36:39], a[124:127], v[108:111]
    ds_read_b128 a[156:159], v244 offset:6144
    ds_read_b64_tr_b16 a[160:161], v247 offset:128
    v_cvt_pk_bf16_f32 v81, v82, v83
    v_mfma_f32_16x16x32_bf16 v[32:35], a[40:43], a[96:99], v[32:35]
    ds_read_b64_tr_b16 a[162:163], v247 offset:1408
    v_cvt_pk_bf16_f32 v82, v16, v17
    v_mfma_f32_16x16x32_bf16 v[32:35], a[44:47], a[100:103], v[32:35]
    ds_read_b64_tr_b16 a[164:165], v247 offset:10368
    v_cvt_pk_bf16_f32 v83, v18, v19
    v_mfma_f32_16x16x32_bf16 v[36:39], a[40:43], a[104:107], v[36:39]
    buffer_load_dwordx4 v239, s[24:27], s50 offen offset:1024 lds
    v_cvt_pk_bf16_f32 v68, v68, v69
    v_mfma_f32_16x16x32_bf16 v[36:39], a[44:47], a[108:111], v[36:39]
    ds_read_b64_tr_b16 a[166:167], v247 offset:11648
    v_cvt_pk_bf16_f32 v69, v70, v71
    v_mfma_f32_16x16x32_bf16 v[40:43], a[40:43], a[112:115], v[40:43]
    ds_read_b64_tr_b16 a[168:169], v248 offset:160
    v_cvt_pk_bf16_f32 v70, v4, v5
    v_mfma_f32_16x16x32_bf16 v[40:43], a[44:47], a[116:119], v[40:43]
    ds_read_b64_tr_b16 a[170:171], v248 offset:1440
    ds_read_b64_tr_b16 a[172:173], v248 offset:10400
    v_cvt_pk_bf16_f32 v71, v6, v7
    v_mfma_f32_16x16x32_bf16 v[44:47], a[40:43], a[120:123], v[44:47]
    ds_read_b64_tr_b16 a[174:175], v248 offset:11680
    v_cvt_pk_bf16_f32 v84, v84, v85
    v_mfma_f32_16x16x32_bf16 v[44:47], a[44:47], a[124:127], v[44:47]
    ds_read_b64_tr_b16 a[176:177], v229 offset:0
L_pad3:
    s_cbranch_execz L_main
    v_cvt_pk_bf16_f32 v85, v86, v87
    v_mfma_f32_16x16x32_bf16 v[112:115], a[48:51], a[96:99], v[112:115]
    buffer_load_dwordx4 v240, s[24:27], s50 offen offset:2048 lds
    v_mfma_f32_16x16x32_bf16 v[112:115], a[52:55], a[100:103], v[112:115]
    ds_read_b64_tr_b16 a[178:179], v229 offset:1280
    v_cvt_pk_bf16_f32 v86, v20, v21
    v_mfma_f32_16x16x32_bf16 v[116:119], a[48:51], a[104:107], v[116:119]
    ds_read_b64_tr_b16 a[180:181], v229 offset:10240
    v_cvt_pk_bf16_f32 v87, v22, v23
    v_mfma_f32_16x16x32_bf16 v[116:119], a[52:55], a[108:111], v[116:119]
    ds_read_b64_tr_b16 a[182:183], v229 offset:11520
    ds_read_b64_tr_b16 a[184:185], v247 offset:0
    v_cvt_pk_bf16_f32 v72, v72, v73
    v_mfma_f32_16x16x32_bf16 v[120:123], a[48:51], a[112:115], v[120:123]
    ds_read_b64_tr_b16 a[186:187], v247 offset:1280
    v_cvt_pk_bf16_f32 v73, v74, v75
    v_mfma_f32_16x16x32_bf16 v[120:123], a[52:55], a[116:119], v[120:123]
    ds_read_b64_tr_b16 a[188:189], v247 offset:10240
    v_cvt_pk_bf16_f32 v74, v8, v9
    v_cvt_pk_bf16_f32 v75, v10, v11
    v_mfma_f32_16x16x32_bf16 v[124:127], a[48:51], a[120:123], v[124:127]
    buffer_load_dwordx4 v241, s[24:27], s50 offen offset:3072 lds
    v_mfma_f32_16x16x32_bf16 v[124:127], a[52:55], a[124:127], v[124:127]
    ds_read_b64_tr_b16 a[190:191], v247 offset:11520
    v_cvt_pk_bf16_f32 v88, v88, v89
    v_mfma_f32_16x16x32_bf16 v[48:51], a[56:59], a[96:99], v[48:51]
    ds_read_b64_tr_b16 a[0:1], v248 offset:32
    ds_read_b64_tr_b16 a[2:3], v248 offset:1312
    v_cvt_pk_bf16_f32 v89, v90, v91
    v_mfma_f32_16x16x32_bf16 v[48:51], a[60:63], a[100:103], v[48:51]
    ds_read_b64_tr_b16 a[4:5], v248 offset:10272
    v_cvt_pk_bf16_f32 v90, v24, v25
    v_mfma_f32_16x16x32_bf16 v[52:55], a[56:59], a[104:107], v[52:55]
    ds_read_b64_tr_b16 a[6:7], v248 offset:11552
    v_cvt_pk_bf16_f32 v91, v26, v27
    v_mfma_f32_16x16x32_bf16 v[52:55], a[60:63], a[108:111], v[52:55]
    s_add_u32 m0, s81, 77824
    v_cvt_pk_bf16_f32 v76, v76, v77
    v_mfma_f32_16x16x32_bf16 v[56:59], a[56:59], a[112:115], v[56:59]
    buffer_load_dwordx4 v242, s[24:27], s50 offen offset:0 lds
    v_mfma_f32_16x16x32_bf16 v[56:59], a[60:63], a[116:119], v[56:59]
    v_cvt_pk_bf16_f32 v77, v78, v79
    v_cvt_pk_bf16_f32 v78, v12, v13
    v_mfma_f32_16x16x32_bf16 v[60:63], a[56:59], a[120:123], v[60:63]
    v_cvt_pk_bf16_f32 v79, v14, v15
    v_cvt_pk_bf16_f32 v92, v92, v93
    v_mfma_f32_16x16x32_bf16 v[60:63], a[60:63], a[124:127], v[60:63]
    v_cvt_pk_bf16_f32 v93, v94, v95
    v_cvt_pk_bf16_f32 v94, v28, v29
    v_cvt_pk_bf16_f32 v95, v30, v31
    s_waitcnt vmcnt(9) lgkmcnt(0)
    s_barrier
    v_mfma_f32_16x16x32_bf16 v[0:3], a[192:195], v[64:67], 0
    v_cvt_pk_bf16_f32 v96, v96, v97
    v_cvt_pk_bf16_f32 v97, v98, v99
    v_mfma_f32_16x16x32_bf16 v[0:3], a[196:199], v[80:83], v[0:3]
    v_cvt_pk_bf16_f32 v98, v32, v33
    v_cvt_pk_bf16_f32 v99, v34, v35
    v_mfma_f32_16x16x32_bf16 v[4:7], a[208:211], v[64:67], 0
    v_cvt_pk_bf16_f32 v112, v112, v113
    v_cvt_pk_bf16_f32 v113, v114, v115
    v_mfma_f32_16x16x32_bf16 v[4:7], a[212:215], v[80:83], v[4:7]
    v_cvt_pk_bf16_f32 v114, v48, v49
    v_cvt_pk_bf16_f32 v115, v50, v51
    v_mfma_f32_16x16x32_bf16 v[8:11], a[192:195], v[68:71], 0
    v_cvt_pk_bf16_f32 v100, v100, v101
    v_cvt_pk_bf16_f32 v101, v102, v103
    v_mfma_f32_16x16x32_bf16 v[8:11], a[196:199], v[84:87], v[8:11]
    v_cvt_pk_bf16_f32 v102, v36, v37
    v_cvt_pk_bf16_f32 v103, v38, v39
    v_mfma_f32_16x16x32_bf16 v[12:15], a[208:211], v[68:71], 0
    v_cvt_pk_bf16_f32 v116, v116, v117
    v_cvt_pk_bf16_f32 v117, v118, v119
    v_mfma_f32_16x16x32_bf16 v[12:15], a[212:215], v[84:87], v[12:15]
    v_cvt_pk_bf16_f32 v118, v52, v53
    v_cvt_pk_bf16_f32 v119, v54, v55
    v_mfma_f32_16x16x32_bf16 v[16:19], a[224:227], v[72:75], 0
    v_cvt_pk_bf16_f32 v104, v104, v105
    v_cvt_pk_bf16_f32 v105, v106, v107
    v_mfma_f32_16x16x32_bf16 v[16:19], a[228:231], v[88:91], v[16:19]
    v_cvt_pk_bf16_f32 v106, v40, v41
    v_cvt_pk_bf16_f32 v107, v42, v43
    v_mfma_f32_16x16x32_bf16 v[20:23], a[240:243], v[72:75], 0
    v_cvt_pk_bf16_f32 v120, v120, v121
    v_cvt_pk_bf16_f32 v121, v122, v123
    v_mfma_f32_16x16x32_bf16 v[20:23], a[244:247], v[88:91], v[20:23]
    v_cvt_pk_bf16_f32 v122, v56, v57
    v_cvt_pk_bf16_f32 v123, v58, v59
    v_mfma_f32_16x16x32_bf16 v[24:27], a[224:227], v[76:79], 0
    v_cvt_pk_bf16_f32 v108, v108, v109
    v_cvt_pk_bf16_f32 v109, v110, v111
    v_mfma_f32_16x16x32_bf16 v[24:27], a[228:231], v[92:95], v[24:27]
    v_cvt_pk_bf16_f32 v110, v44, v45
    v_cvt_pk_bf16_f32 v111, v46, v47
    v_mfma_f32_16x16x32_bf16 v[28:31], a[240:243], v[76:79], 0
    v_cvt_pk_bf16_f32 v124, v124, v125
    v_cvt_pk_bf16_f32 v125, v126, v127
    v_mfma_f32_16x16x32_bf16 v[28:31], a[244:247], v[92:95], v[28:31]
    v_cvt_pk_bf16_f32 v126, v60, v61
    v_cvt_pk_bf16_f32 v127, v62, v63
    v_mfma_f32_16x16x32_bf16 v[0:3], a[200:203], v[96:99], v[0:3]
    ds_read_b128 a[8:11], v243 offset:36864
    v_mfma_f32_16x16x32_bf16 v[0:3], a[204:207], v[112:115], v[0:3]
    ds_read_b128 a[12:15], v244 offset:36864
    v_mfma_f32_16x16x32_bf16 v[4:7], a[216:219], v[96:99], v[4:7]
    ds_read_b128 a[16:19], v243 offset:38912
    v_mfma_f32_16x16x32_bf16 v[4:7], a[220:223], v[112:115], v[4:7]
    ds_read_b128 a[20:23], v244 offset:38912
    s_add_u32 m0, s79, 110464
    v_mfma_f32_16x16x32_bf16 v[8:11], a[200:203], v[100:103], v[8:11]
    buffer_load_dwordx4 v234, s[16:19], s41 offen offset:128 lds
    v_mfma_f32_16x16x32_bf16 v[8:11], a[204:207], v[116:119], v[8:11]
    ds_read_b128 a[24:27], v243 offset:40960
    v_mfma_f32_16x16x32_bf16 v[12:15], a[216:219], v[100:103], v[12:15]
    ds_read_b128 a[28:31], v244 offset:40960
    v_mfma_f32_16x16x32_bf16 v[12:15], a[220:223], v[116:119], v[12:15]
    ds_read_b128 a[32:35], v243 offset:43008
    v_mfma_f32_16x16x32_bf16 v[16:19], a[232:235], v[104:107], v[16:19]
    ds_read_b128 a[36:39], v244 offset:43008
    v_max3_f32 v32, v0, v1, v2
    v_mfma_f32_16x16x32_bf16 v[16:19], a[236:239], v[120:123], v[16:19]
    ds_read_b64_tr_b16 a[40:41], v247 offset:36992
    v_max3_f32 v32, v32, v3, v4
    v_mfma_f32_16x16x32_bf16 v[20:23], a[248:251], v[104:107], v[20:23]
    buffer_load_dwordx4 v235, s[16:19], s41 offen offset:1152 lds
    v_mfma_f32_16x16x32_bf16 v[20:23], a[252:255], v[120:123], v[20:23]
    ds_read_b64_tr_b16 a[42:43], v247 offset:38272
    v_max3_f32 v32, v32, v5, v6
    v_mfma_f32_16x16x32_bf16 v[24:27], a[232:235], v[108:111], v[24:27]
    ds_read_b64_tr_b16 a[44:45], v247 offset:47232
    v_max_f32 v32, v32, v7
    v_mfma_f32_16x16x32_bf16 v[24:27], a[236:239], v[124:127], v[24:27]
    ds_read_b64_tr_b16 a[46:47], v247 offset:48512
    v_max3_f32 v33, v8, v9, v10
    v_mfma_f32_16x16x32_bf16 v[28:31], a[248:251], v[108:111], v[28:31]
    ds_read_b64_tr_b16 a[48:49], v248 offset:37024
    v_max3_f32 v33, v33, v11, v12
    v_mfma_f32_16x16x32_bf16 v[28:31], a[252:255], v[124:127], v[28:31]
    ds_read_b64_tr_b16 a[50:51], v248 offset:38304
    v_max3_f32 v33, v33, v13, v14
    v_mfma_f32_16x16x32_bf16 v[168:171], a[144:147], a[160:163], 0
    buffer_load_dwordx4 v236, s[16:19], s41 offen offset:2176 lds
    v_mfma_f32_16x16x32_bf16 v[168:171], a[148:151], a[164:167], v[168:171]
    ds_read_b64_tr_b16 a[52:53], v248 offset:47264
    v_max_f32 v33, v33, v15
    v_mfma_f32_16x16x32_bf16 v[172:175], a[152:155], a[160:163], 0
    ds_read_b64_tr_b16 a[54:55], v248 offset:48544
    v_max3_f32 v34, v16, v17, v18
    v_mfma_f32_16x16x32_bf16 v[172:175], a[156:159], a[164:167], v[172:175]
    ds_read_b64_tr_b16 a[56:57], v229 offset:36864
    v_max3_f32 v34, v34, v19, v20
    v_max3_f32 v34, v34, v21, v22
    v_mfma_f32_16x16x32_bf16 v[176:179], a[144:147], a[168:171], 0
    ds_read_b64_tr_b16 a[58:59], v229 offset:38144
    v_max_f32 v34, v34, v23
    v_max3_f32 v35, v24, v25, v26
    v_mfma_f32_16x16x32_bf16 v[176:179], a[148:151], a[172:175], v[176:179]
    ds_read_b64_tr_b16 a[60:61], v229 offset:47104
    v_max3_f32 v35, v35, v27, v28
    v_max3_f32 v35, v35, v29, v30
    v_mfma_f32_16x16x32_bf16 v[180:183], a[152:155], a[168:171], 0
    buffer_load_dwordx4 v237, s[16:19], s41 offen offset:3200 lds
    v_max_f32 v35, v35, v31
    v_mfma_f32_16x16x32_bf16 v[180:183], a[156:159], a[172:175], v[180:183]
    ds_read_b64_tr_b16 a[62:63], v229 offset:48384
    v_permlane32_swap_b32 v32, v33
    v_permlane32_swap_b32 v34, v35
    v_mfma_f32_16x16x32_bf16 v[184:187], a[144:147], a[176:179], 0
    ds_read_b64_tr_b16 a[64:65], v247 offset:36864
    v_max_f32 v32, v32, v33
    v_max_f32 v34, v34, v35
    v_mfma_f32_16x16x32_bf16 v[184:187], a[148:151], a[180:183], v[184:187]
    ds_read_b64_tr_b16 a[66:67], v247 offset:38144
    v_permlane16_swap_b32 v32, v34
    v_max_f32 v32, v32, v34
    v_mul_f32 v32, s99, v32
    v_mfma_f32_16x16x32_bf16 v[188:191], a[152:155], a[176:179], 0
    ds_read_b64_tr_b16 a[68:69], v247 offset:47104
    v_mov_b32 v34, v32
    s_nop 1
    v_permlane16_swap_b32 v32, v34
    v_mfma_f32_16x16x32_bf16 v[188:191], a[156:159], a[180:183], v[188:191]
    ds_read_b64_tr_b16 a[70:71], v247 offset:48384
    s_add_u32 m0, s81, 110592
    v_mov_b32 v33, v32
    v_mfma_f32_16x16x32_bf16 v[192:195], a[144:147], a[184:187], 0
    buffer_load_dwordx4 v238, s[24:27], s51 offen offset:0 lds
    v_mov_b32 v35, v34
    v_mfma_f32_16x16x32_bf16 v[192:195], a[148:151], a[188:191], v[192:195]
    ds_read_b64_tr_b16 a[72:73], v248 offset:36896
    v_permlane32_swap_b32 v32, v33
    v_permlane32_swap_b32 v34, v35
    v_pk_fma_f32 v[0:1], v[0:1], s[98:99], v[32:33] op_sel:[0,1,0] op_sel_hi:[1,1,0] neg_lo:[0,0,1] neg_hi:[0,0,1]
    v_pk_fma_f32 v[2:3], v[2:3], s[98:99], v[32:33] op_sel:[0,1,0] op_sel_hi:[1,1,0] neg_lo:[0,0,1] neg_hi:[0,0,1]
    v_pk_fma_f32 v[4:5], v[4:5], s[98:99], v[32:33] op_sel:[0,1,0] op_sel_hi:[1,1,0] neg_lo:[0,0,1] neg_hi:[0,0,1]
    v_pk_fma_f32 v[6:7], v[6:7], s[98:99], v[32:33] op_sel:[0,1,0] op_sel_hi:[1,1,0] neg_lo:[0,0,1] neg_hi:[0,0,1]
    v_pk_fma_f32 v[8:9], v[8:9], s[98:99], v[32:33] op_sel:[0,1,1] op_sel_hi:[1,1,1] neg_lo:[0,0,1] neg_hi:[0,0,1]
    v_pk_fma_f32 v[10:11], v[10:11], s[98:99], v[32:33] op_sel:[0,1,1] op_sel_hi:[1,1,1] neg_lo:[0,0,1] neg_hi:[0,0,1]
    v_pk_fma_f32 v[12:13], v[12:13], s[98:99], v[32:33] op_sel:[0,1,1] op_sel_hi:[1,1,1] neg_lo:[0,0,1] neg_hi:[0,0,1]
    v_pk_fma_f32 v[14:15], v[14:15], s[98:99], v[32:33] op_sel:[0,1,1] op_sel_hi:[1,1,1] neg_lo:[0,0,1] neg_hi:[0,0,1]
    v_pk_fma_f32 v[16:17], v[16:17], s[98:99], v[34:35] op_sel:[0,1,0] op_sel_hi:[1,1,0] neg_lo:[0,0,1] neg_hi:[0,0,1]
    v_pk_fma_f32 v[18:19], v[18:19], s[98:99], v[34:35] op_sel:[0,1,0] op_sel_hi:[1,1,0] neg_lo:[0,0,1] neg_hi:[0,0,1]
    v_pk_fma_f32 v[20:21], v[20:21], s[98:99], v[34:35] op_sel:[0,1,0] op_sel_hi:[1,1,0] neg_lo:[0,0,1] neg_hi:[0,0,1]
    v_pk_fma_f32 v[22:23], v[22:23], s[98:99], v[34:35] op_sel:[0,1,0] op_sel_hi:[1,1,0] neg_lo:[0,0,1] neg_hi:[0,0,1]
    v_pk_fma_f32 v[24:25], v[24:25], s[98:99], v[34:35] op_sel:[0,1,1] op_sel_hi:[1,1,1] neg_lo:[0,0,1] neg_hi:[0,0,1]
    v_pk_fma_f32 v[26:27], v[26:27], s[98:99], v[34:35] op_sel:[0,1,1] op_sel_hi:[1,1,1] neg_lo:[0,0,1] neg_hi:[0,0,1]
    v_pk_fma_f32 v[28:29], v[28:29], s[98:99], v[34:35] op_sel:[0,1,1] op_sel_hi:[1,1,1] neg_lo:[0,0,1] neg_hi:[0,0,1]
    v_pk_fma_f32 v[30:31], v[30:31], s[98:99], v[34:35] op_sel:[0,1,1] op_sel_hi:[1,1,1] neg_lo:[0,0,1] neg_hi:[0,0,1]
    v_mfma_f32_16x16x32_bf16 v[196:199], a[152:155], a[184:187], 0
    ds_read_b64_tr_b16 a[74:75], v248 offset:38176
    v_exp_f32 v0, v0
    v_mfma_f32_16x16x32_bf16 v[196:199], a[156:159], a[188:191], v[196:199]
    ds_read_b64_tr_b16 a[76:77], v248 offset:47136
    v_exp_f32 v1, v1
    v_mfma_f32_16x16x32_bf16 v[200:203], a[144:147], a[0:3], 0
    ds_read_b64_tr_b16 a[78:79], v248 offset:48416
    v_exp_f32 v2, v2
    v_mfma_f32_16x16x32_bf16 v[200:203], a[148:151], a[4:7], v[200:203]
    v_exp_f32 v3, v3
    v_exp_f32 v4, v4
    v_mfma_f32_16x16x32_bf16 v[204:207], a[152:155], a[0:3], 0
    buffer_load_dwordx4 v239, s[24:27], s51 offen offset:1024 lds
    v_mfma_f32_16x16x32_bf16 v[204:207], a[156:159], a[4:7], v[204:207]
    v_exp_f32 v5, v5
    v_exp_f32 v6, v6
    v_mfma_f32_16x16x32_bf16 v[128:131], a[128:131], a[160:163], 0
    v_exp_f32 v7, v7
    v_mfma_f32_16x16x32_bf16 v[128:131], a[132:135], a[164:167], v[128:131]
    v_exp_f32 v8, v8
    v_exp_f32 v9, v9
    v_mfma_f32_16x16x32_bf16 v[132:135], a[136:139], a[160:163], 0
    v_exp_f32 v10, v10
    v_mfma_f32_16x16x32_bf16 v[132:135], a[140:143], a[164:167], v[132:135]
    v_exp_f32 v11, v11
    v_exp_f32 v12, v12
    v_mfma_f32_16x16x32_bf16 v[136:139], a[128:131], a[168:171], 0
    buffer_load_dwordx4 v240, s[24:27], s51 offen offset:2048 lds
    v_exp_f32 v13, v13
    v_mfma_f32_16x16x32_bf16 v[136:139], a[132:135], a[172:175], v[136:139]
    v_exp_f32 v14, v14
    v_mfma_f32_16x16x32_bf16 v[140:143], a[136:139], a[168:171], 0
    v_exp_f32 v15, v15
    v_exp_f32 v16, v16
    v_mfma_f32_16x16x32_bf16 v[140:143], a[140:143], a[172:175], v[140:143]
    v_exp_f32 v17, v17
    v_mfma_f32_16x16x32_bf16 v[144:147], a[128:131], a[176:179], 0
    v_exp_f32 v18, v18
    v_exp_f32 v19, v19
    v_mfma_f32_16x16x32_bf16 v[144:147], a[132:135], a[180:183], v[144:147]
    v_exp_f32 v20, v20
    v_mfma_f32_16x16x32_bf16 v[148:151], a[136:139], a[176:179], 0
    buffer_load_dwordx4 v241, s[24:27], s51 offen offset:3072 lds
    v_exp_f32 v21, v21
    v_mfma_f32_16x16x32_bf16 v[148:151], a[140:143], a[180:183], v[148:151]
    v_exp_f32 v22, v22
    v_exp_f32 v23, v23
    v_mfma_f32_16x16x32_bf16 v[152:155], a[128:131], a[184:187], 0
    v_exp_f32 v24, v24
    v_mfma_f32_16x16x32_bf16 v[152:155], a[132:135], a[188:191], v[152:155]
    v_exp_f32 v25, v25
    v_exp_f32 v26, v26
    v_mfma_f32_16x16x32_bf16 v[156:159], a[136:139], a[184:187], 0
    v_exp_f32 v27, v27
    v_mfma_f32_16x16x32_bf16 v[156:159], a[140:143], a[188:191], v[156:159]
    s_add_u32 m0, s81, 114688
    v_exp_f32 v28, v28
    v_mfma_f32_16x16x32_bf16 v[160:163], a[128:131], a[0:3], 0
    buffer_load_dwordx4 v242, s[24:27], s51 offen offset:0 lds
    v_exp_f32 v29, v29
    v_mfma_f32_16x16x32_bf16 v[160:163], a[132:135], a[4:7], v[160:163]
    v_exp_f32 v30, v30
    v_exp_f32 v31, v31
    v_pk_add_f32 v[40:41], v[0:1], v[2:3]
    v_pk_add_f32 v[42:43], v[8:9], v[10:11]
    v_pk_add_f32 v[44:45], v[16:17], v[18:19]
    v_pk_add_f32 v[46:47], v[24:25], v[26:27]
    v_pk_add_f32 v[40:41], v[40:41], v[4:5]
    v_pk_add_f32 v[42:43], v[42:43], v[12:13]
    v_pk_add_f32 v[44:45], v[44:45], v[20:21]
    v_pk_add_f32 v[46:47], v[46:47], v[28:29]
    v_pk_add_f32 v[40:41], v[40:41], v[6:7]
    v_pk_add_f32 v[42:43], v[42:43], v[14:15]
    v_pk_add_f32 v[44:45], v[44:45], v[22:23]
    v_pk_add_f32 v[46:47], v[46:47], v[30:31]
    v_mfma_f32_16x16x32_bf16 v[164:167], a[136:139], a[0:3], 0
    v_add_f32 v32, v40, v41
    v_add_f32 v33, v42, v43
    v_add_f32 v34, v44, v45
    v_mfma_f32_16x16x32_bf16 v[164:167], a[140:143], a[4:7], v[164:167]
    v_add_f32 v35, v46, v47
    v_permlane32_swap_b32 v32, v33
    s_nop 0
    v_permlane32_swap_b32 v34, v35
    s_waitcnt vmcnt(9) lgkmcnt(0)
    s_barrier
    v_mfma_f32_16x16x32_bf16 v[168:171], a[24:27], a[40:43], v[168:171]
    ds_read_b128 a[128:131], v245 offset:0
    v_add_f32 v32, v32, v33
    v_add_f32 v34, v34, v35
    v_mfma_f32_16x16x32_bf16 v[168:171], a[28:31], a[44:47], v[168:171]
    ds_read_b128 a[132:135], v246 offset:0
    v_permlane16_swap_b32 v32, v34
    v_add_f32 v32, v32, v34
    v_mfma_f32_16x16x32_bf16 v[172:175], a[32:35], a[40:43], v[172:175]
    ds_read_b128 a[136:139], v245 offset:2048
    s_add_u32 m0, s79, 0
    v_mfma_f32_16x16x32_bf16 v[172:175], a[36:39], a[44:47], v[172:175]
    buffer_load_dwordx4 v234, s[16:19], s42 offen offset:0 lds
    v_rcp_f32 v32, v32
    v_mfma_f32_16x16x32_bf16 v[176:179], a[24:27], a[48:51], v[176:179]
    ds_read_b128 a[140:143], v246 offset:2048
    v_mov_b32 v34, v32
    s_nop 1
    v_permlane16_swap_b32 v32, v34
    v_mfma_f32_16x16x32_bf16 v[176:179], a[28:31], a[52:55], v[176:179]
    ds_read_b128 a[144:147], v245 offset:4096
    v_mov_b32 v33, v32
    v_mov_b32 v35, v34
    v_mfma_f32_16x16x32_bf16 v[180:183], a[32:35], a[48:51], v[180:183]
    ds_read_b128 a[148:151], v246 offset:4096
    v_permlane32_swap_b32 v32, v33
    v_permlane32_swap_b32 v34, v35
    v_pk_mul_f32 v[0:1], v[0:1], v[32:33] op_sel:[0,0] op_sel_hi:[1,0]
    v_pk_mul_f32 v[2:3], v[2:3], v[32:33] op_sel:[0,0] op_sel_hi:[1,0]
    v_pk_mul_f32 v[4:5], v[4:5], v[32:33] op_sel:[0,0] op_sel_hi:[1,0]
    v_pk_mul_f32 v[6:7], v[6:7], v[32:33] op_sel:[0,0] op_sel_hi:[1,0]
    v_pk_mul_f32 v[8:9], v[8:9], v[32:33] op_sel:[0,1] op_sel_hi:[1,1]
    v_pk_mul_f32 v[10:11], v[10:11], v[32:33] op_sel:[0,1] op_sel_hi:[1,1]
    v_pk_mul_f32 v[12:13], v[12:13], v[32:33] op_sel:[0,1] op_sel_hi:[1,1]
    v_pk_mul_f32 v[14:15], v[14:15], v[32:33] op_sel:[0,1] op_sel_hi:[1,1]
    v_pk_mul_f32 v[16:17], v[16:17], v[34:35] op_sel:[0,0] op_sel_hi:[1,0]
    v_pk_mul_f32 v[18:19], v[18:19], v[34:35] op_sel:[0,0] op_sel_hi:[1,0]
    v_pk_mul_f32 v[20:21], v[20:21], v[34:35] op_sel:[0,0] op_sel_hi:[1,0]
    v_pk_mul_f32 v[22:23], v[22:23], v[34:35] op_sel:[0,0] op_sel_hi:[1,0]
    v_pk_mul_f32 v[24:25], v[24:25], v[34:35] op_sel:[0,1] op_sel_hi:[1,1]
    v_pk_mul_f32 v[26:27], v[26:27], v[34:35] op_sel:[0,1] op_sel_hi:[1,1]
    v_pk_mul_f32 v[28:29], v[28:29], v[34:35] op_sel:[0,1] op_sel_hi:[1,1]
    v_pk_mul_f32 v[30:31], v[30:31], v[34:35] op_sel:[0,1] op_sel_hi:[1,1]
    v_mfma_f32_16x16x32_bf16 v[180:183], a[36:39], a[52:55], v[180:183]
    buffer_load_dwordx4 v235, s[16:19], s42 offen offset:1024 lds
    v_cvt_pk_bf16_f32 v208, v0, v1
    v_cvt_pk_bf16_f32 v209, v2, v3
    v_mfma_f32_16x16x32_bf16 v[184:187], a[24:27], a[56:59], v[184:187]
    ds_read_b128 a[152:155], v245 offset:6144
    v_cvt_pk_bf16_f32 v210, v4, v5
    v_cvt_pk_bf16_f32 v211, v6, v7
    v_mfma_f32_16x16x32_bf16 v[184:187], a[28:31], a[60:63], v[184:187]
    ds_read_b128 a[156:159], v246 offset:6144
    v_xor_b32 v208, v224, v208
    v_xor_b32 v210, v225, v210
    v_mfma_f32_16x16x32_bf16 v[188:191], a[32:35], a[56:59], v[188:191]
    ds_read_b64_tr_b16 a[160:161], v249 offset:128
    buffer_store_dwordx4 v[208:211], v232, s[36:39], s91 offen offset:0 sc1
    ds_write_b128 v228, v[208:211] offset:0
    v_mfma_f32_16x16x32_bf16 v[188:191], a[36:39], a[60:63], v[188:191]
    buffer_load_dwordx4 v236, s[16:19], s42 offen offset:2048 lds
    v_cvt_pk_bf16_f32 v212, v8, v9
    v_mfma_f32_16x16x32_bf16 v[192:195], a[24:27], a[64:67], v[192:195]
    ds_read_b64_tr_b16 a[162:163], v249 offset:1408
    v_cvt_pk_bf16_f32 v213, v10, v11
    v_cvt_pk_bf16_f32 v214, v12, v13
    v_mfma_f32_16x16x32_bf16 v[192:195], a[28:31], a[68:71], v[192:195]
    ds_read_b64_tr_b16 a[164:165], v249 offset:10368
    v_cvt_pk_bf16_f32 v215, v14, v15
    v_xor_b32 v212, v224, v212
    v_mfma_f32_16x16x32_bf16 v[196:199], a[32:35], a[64:67], v[196:199]
    ds_read_b64_tr_b16 a[166:167], v249 offset:11648
    v_xor_b32 v214, v225, v214
    buffer_store_dwordx4 v[212:215], v232, s[36:39], s91 offen offset:1024 sc1
    v_mfma_f32_16x16x32_bf16 v[196:199], a[36:39], a[68:71], v[196:199]
    ds_read_b64_tr_b16 a[168:169], v250 offset:160
    ds_write_b128 v228, v[212:215] offset:1024
    v_cvt_pk_bf16_f32 v216, v16, v17
    v_cvt_pk_bf16_f32 v217, v18, v19
    v_mfma_f32_16x16x32_bf16 v[200:203], a[24:27], a[72:75], v[200:203]
    buffer_load_dwordx4 v237, s[16:19], s42 offen offset:3072 lds
    v_cvt_pk_bf16_f32 v218, v20, v21
    v_mfma_f32_16x16x32_bf16 v[200:203], a[28:31], a[76:79], v[200:203]
    ds_read_b64_tr_b16 a[170:171], v250 offset:1440
    ds_read_b64_tr_b16 a[172:173], v250 offset:10400
    v_cvt_pk_bf16_f32 v219, v22, v23
    v_xor_b32 v216, v224, v216
    v_mfma_f32_16x16x32_bf16 v[204:207], a[32:35], a[72:75], v[204:207]
    ds_read_b64_tr_b16 a[174:175], v250 offset:11680
    v_xor_b32 v218, v225, v218
    buffer_store_dwordx4 v[216:219], v232, s[36:39], s91 offen offset:2048 sc1
    v_mfma_f32_16x16x32_bf16 v[204:207], a[36:39], a[76:79], v[204:207]
    ds_read_b64_tr_b16 a[176:177], v253 offset:0
    s_add_u32 m0, s81, 0
    ds_write_b128 v228, v[216:219] offset:2048
    v_mfma_f32_16x16x32_bf16 v[128:131], a[8:11], a[40:43], v[128:131]
    buffer_load_dwordx4 v238, s[24:27], s52 offen offset:0 lds
    v_cvt_pk_bf16_f32 v220, v24, v25
    v_mfma_f32_16x16x32_bf16 v[128:131], a[12:15], a[44:47], v[128:131]
    ds_read_b64_tr_b16 a[178:179], v253 offset:1280
    v_cvt_pk_bf16_f32 v221, v26, v27
    v_cvt_pk_bf16_f32 v222, v28, v29
    v_mfma_f32_16x16x32_bf16 v[132:135], a[16:19], a[40:43], v[132:135]
    ds_read_b64_tr_b16 a[180:181], v253 offset:10240
    v_cvt_pk_bf16_f32 v223, v30, v31
    v_xor_b32 v220, v224, v220
    v_mfma_f32_16x16x32_bf16 v[132:135], a[20:23], a[44:47], v[132:135]
    ds_read_b64_tr_b16 a[182:183], v253 offset:11520
    v_xor_b32 v222, v225, v222
    buffer_store_dwordx4 v[220:223], v232, s[36:39], s91 offen offset:3072 sc1
    ds_write_b128 v228, v[220:223] offset:3072
    v_mfma_f32_16x16x32_bf16 v[136:139], a[8:11], a[48:51], v[136:139]
    buffer_load_dwordx4 v239, s[24:27], s52 offen offset:1024 lds
    v_mfma_f32_16x16x32_bf16 v[136:139], a[12:15], a[52:55], v[136:139]
    ds_read_b64_tr_b16 a[184:185], v249 offset:0
    v_cvt_pk_bf16_f32 v100, v168, v169
    v_mfma_f32_16x16x32_bf16 v[140:143], a[16:19], a[48:51], v[140:143]
    ds_read_b64_tr_b16 a[186:187], v249 offset:1280
    v_cvt_pk_bf16_f32 v101, v170, v171
    v_mfma_f32_16x16x32_bf16 v[140:143], a[20:23], a[52:55], v[140:143]
    ds_read_b64_tr_b16 a[188:189], v249 offset:10240
    v_cvt_pk_bf16_f32 v102, v172, v173
    v_mfma_f32_16x16x32_bf16 v[144:147], a[8:11], a[56:59], v[144:147]
    ds_read_b64_tr_b16 a[190:191], v249 offset:11520
    v_cvt_pk_bf16_f32 v103, v174, v175
    v_mfma_f32_16x16x32_bf16 v[144:147], a[12:15], a[60:63], v[144:147]
    buffer_load_dwordx4 v240, s[24:27], s52 offen offset:2048 lds
    v_mfma_f32_16x16x32_bf16 v[148:151], a[16:19], a[56:59], v[148:151]
    ds_read_b64_tr_b16 a[0:1], v250 offset:32
    v_cvt_pk_bf16_f32 v104, v176, v177
    v_mfma_f32_16x16x32_bf16 v[148:151], a[20:23], a[60:63], v[148:151]
    ds_read_b64_tr_b16 a[2:3], v250 offset:1312
    v_cvt_pk_bf16_f32 v105, v178, v179
    v_mfma_f32_16x16x32_bf16 v[152:155], a[8:11], a[64:67], v[152:155]
    ds_read_b64_tr_b16 a[4:5], v250 offset:10272
    v_cvt_pk_bf16_f32 v106, v180, v181
    v_mfma_f32_16x16x32_bf16 v[152:155], a[12:15], a[68:71], v[152:155]
    buffer_load_dwordx4 v241, s[24:27], s52 offen offset:3072 lds
    v_mfma_f32_16x16x32_bf16 v[156:159], a[16:19], a[64:67], v[156:159]
    ds_read_b64_tr_b16 a[6:7], v250 offset:11552
    v_cvt_pk_bf16_f32 v107, v182, v183
    v_mfma_f32_16x16x32_bf16 v[156:159], a[20:23], a[68:71], v[156:159]
    v_cvt_pk_bf16_f32 v108, v184, v185
    v_cvt_pk_bf16_f32 v109, v186, v187
    v_mfma_f32_16x16x32_bf16 v[160:163], a[8:11], a[72:75], v[160:163]
    s_add_u32 m0, s81, 4096
    v_cvt_pk_bf16_f32 v110, v188, v189
    v_mfma_f32_16x16x32_bf16 v[160:163], a[12:15], a[76:79], v[160:163]
    buffer_load_dwordx4 v242, s[24:27], s52 offen offset:0 lds
    v_mfma_f32_16x16x32_bf16 v[164:167], a[16:19], a[72:75], v[164:167]
    v_cvt_pk_bf16_f32 v111, v190, v191
    v_cvt_pk_bf16_f32 v112, v192, v193
    v_mfma_f32_16x16x32_bf16 v[164:167], a[20:23], a[76:79], v[164:167]
    v_cvt_pk_bf16_f32 v113, v194, v195
    v_cvt_pk_bf16_f32 v114, v196, v197
    s_waitcnt vmcnt(13) lgkmcnt(0)
    s_barrier
    v_mfma_f32_16x16x32_bf16 v[168:171], a[144:147], a[160:163], 0
    ds_read_b128 v[208:211], v251 offset:0
    v_cvt_pk_bf16_f32 v115, v198, v199
    v_mfma_f32_16x16x32_bf16 v[168:171], a[148:151], a[164:167], v[168:171]
    ds_read_b128 v[212:215], v251 offset:1024
    v_cvt_pk_bf16_f32 v116, v200, v201
    v_mfma_f32_16x16x32_bf16 v[172:175], a[152:155], a[160:163], 0
    ds_read_b128 v[216:219], v251 offset:2048
    s_add_u32 m0, s79, 36736
    v_mfma_f32_16x16x32_bf16 v[172:175], a[156:159], a[164:167], v[172:175]
    buffer_load_dwordx4 v234, s[16:19], s42 offen offset:128 lds
    v_mfma_f32_16x16x32_bf16 v[176:179], a[144:147], a[168:171], 0
    ds_read_b128 v[220:223], v251 offset:3072
    v_cvt_pk_bf16_f32 v117, v202, v203
    v_mfma_f32_16x16x32_bf16 v[176:179], a[148:151], a[172:175], v[176:179]
    ds_read_b128 a[8:11], v245 offset:36864
    v_cvt_pk_bf16_f32 v118, v204, v205
    v_mfma_f32_16x16x32_bf16 v[180:183], a[152:155], a[168:171], 0
    ds_read_b128 a[12:15], v246 offset:36864
    v_cvt_pk_bf16_f32 v119, v206, v207
    v_mfma_f32_16x16x32_bf16 v[180:183], a[156:159], a[172:175], v[180:183]
    ds_read_b128 a[16:19], v245 offset:38912
    v_cvt_pk_bf16_f32 v80, v128, v129
    v_mfma_f32_16x16x32_bf16 v[184:187], a[144:147], a[176:179], 0
    ds_read_b128 a[20:23], v246 offset:38912
    v_cvt_pk_bf16_f32 v81, v130, v131
    v_mfma_f32_16x16x32_bf16 v[184:187], a[148:151], a[180:183], v[184:187]
    buffer_load_dwordx4 v235, s[16:19], s42 offen offset:1152 lds
    v_mfma_f32_16x16x32_bf16 v[188:191], a[152:155], a[176:179], 0
    ds_read_b128 a[24:27], v245 offset:40960
    v_cvt_pk_bf16_f32 v82, v132, v133
    v_mfma_f32_16x16x32_bf16 v[188:191], a[156:159], a[180:183], v[188:191]
    ds_read_b128 a[28:31], v246 offset:40960
    v_cvt_pk_bf16_f32 v83, v134, v135
    v_mfma_f32_16x16x32_bf16 v[192:195], a[144:147], a[184:187], 0
    ds_read_b128 a[32:35], v245 offset:43008
    v_cvt_pk_bf16_f32 v84, v136, v137
    v_mfma_f32_16x16x32_bf16 v[192:195], a[148:151], a[188:191], v[192:195]
    ds_read_b128 a[36:39], v246 offset:43008
    v_cvt_pk_bf16_f32 v85, v138, v139
    v_mfma_f32_16x16x32_bf16 v[196:199], a[152:155], a[184:187], 0
    buffer_load_dwordx4 v236, s[16:19], s42 offen offset:2176 lds
    v_mfma_f32_16x16x32_bf16 v[196:199], a[156:159], a[188:191], v[196:199]
    ds_read_b64_tr_b16 a[40:41], v249 offset:36992
    v_cvt_pk_bf16_f32 v86, v140, v141
    v_cvt_pk_bf16_f32 v87, v142, v143
    v_mfma_f32_16x16x32_bf16 v[200:203], a[144:147], a[0:3], 0
    ds_read_b64_tr_b16 a[42:43], v249 offset:38272
    v_cvt_pk_bf16_f32 v88, v144, v145
    v_mfma_f32_16x16x32_bf16 v[200:203], a[148:151], a[4:7], v[200:203]
    ds_read_b64_tr_b16 a[44:45], v249 offset:47232
    v_cvt_pk_bf16_f32 v89, v146, v147
    v_mfma_f32_16x16x32_bf16 v[204:207], a[152:155], a[0:3], 0
    ds_read_b64_tr_b16 a[46:47], v249 offset:48512
    v_cvt_pk_bf16_f32 v90, v148, v149
    v_mfma_f32_16x16x32_bf16 v[204:207], a[156:159], a[4:7], v[204:207]
    ds_read_b64_tr_b16 a[48:49], v250 offset:37024
    v_cvt_pk_bf16_f32 v91, v150, v151
    v_mfma_f32_16x16x32_bf16 v[128:131], a[128:131], a[160:163], 0
    buffer_load_dwordx4 v237, s[16:19], s42 offen offset:3200 lds
    v_mfma_f32_16x16x32_bf16 v[128:131], a[132:135], a[164:167], v[128:131]
    ds_read_b64_tr_b16 a[50:51], v250 offset:38304
    v_cvt_pk_bf16_f32 v92, v152, v153
    v_mfma_f32_16x16x32_bf16 v[132:135], a[136:139], a[160:163], 0
    ds_read_b64_tr_b16 a[52:53], v250 offset:47264
    v_cvt_pk_bf16_f32 v93, v154, v155
    v_mfma_f32_16x16x32_bf16 v[132:135], a[140:143], a[164:167], v[132:135]
    ds_read_b64_tr_b16 a[54:55], v250 offset:48544
    v_cvt_pk_bf16_f32 v94, v156, v157
    v_cvt_pk_bf16_f32 v95, v158, v159
    v_mfma_f32_16x16x32_bf16 v[136:139], a[128:131], a[168:171], 0
    ds_read_b64_tr_b16 a[56:57], v253 offset:36864
    s_add_u32 m0, s81, 36864
    v_mfma_f32_16x16x32_bf16 v[136:139], a[132:135], a[172:175], v[136:139]
    buffer_load_dwordx4 v238, s[24:27], s53 offen offset:0 lds
    v_mfma_f32_16x16x32_bf16 v[140:143], a[136:139], a[168:171], 0
    ds_read_b64_tr_b16 a[58:59], v253 offset:38144
    v_cvt_pk_bf16_f32 v96, v160, v161
    v_mfma_f32_16x16x32_bf16 v[140:143], a[140:143], a[172:175], v[140:143]
    ds_read_b64_tr_b16 a[60:61], v253 offset:47104
    v_cvt_pk_bf16_f32 v97, v162, v163
    v_mfma_f32_16x16x32_bf16 v[144:147], a[128:131], a[176:179], 0
    ds_read_b64_tr_b16 a[62:63], v253 offset:48384
    v_cvt_pk_bf16_f32 v98, v164, v165
    v_mfma_f32_16x16x32_bf16 v[144:147], a[132:135], a[180:183], v[144:147]
    ds_read_b64_tr_b16 a[64:65], v249 offset:36864
    v_cvt_pk_bf16_f32 v99, v166, v167
    v_mfma_f32_16x16x32_bf16 v[148:151], a[136:139], a[176:179], 0
    buffer_load_dwordx4 v239, s[24:27], s53 offen offset:1024 lds
    v_mfma_f32_16x16x32_bf16 v[148:151], a[140:143], a[180:183], v[148:151]
    ds_read_b64_tr_b16 a[66:67], v249 offset:38144
    s_waitcnt lgkmcnt(15)
    v_xor_b32 v208, v224, v208
    v_mfma_f32_16x16x32_bf16 v[152:155], a[128:131], a[184:187], 0
    ds_read_b64_tr_b16 a[68:69], v249 offset:47104
    v_xor_b32 v210, v225, v210
    v_mfma_f32_16x16x32_bf16 v[152:155], a[132:135], a[188:191], v[152:155]
    ds_read_b64_tr_b16 a[70:71], v249 offset:48384
    v_xor_b32 v212, v224, v212
    v_mfma_f32_16x16x32_bf16 v[156:159], a[136:139], a[184:187], 0
    ds_read_b64_tr_b16 a[72:73], v250 offset:36896
    v_xor_b32 v214, v225, v214
    v_mfma_f32_16x16x32_bf16 v[156:159], a[140:143], a[188:191], v[156:159]
    ds_read_b64_tr_b16 a[74:75], v250 offset:38176
    v_xor_b32 v216, v224, v216
L_pad4:
    s_cbranch_execz L_hop2
    v_mfma_f32_16x16x32_bf16 v[160:163], a[128:131], a[0:3], 0
    buffer_load_dwordx4 v240, s[24:27], s53 offen offset:2048 lds
    v_mfma_f32_16x16x32_bf16 v[160:163], a[132:135], a[4:7], v[160:163]
    ds_read_b64_tr_b16 a[76:77], v250 offset:47136
    v_xor_b32 v218, v225, v218
    v_mfma_f32_16x16x32_bf16 v[164:167], a[136:139], a[0:3], 0
    ds_read_b64_tr_b16 a[78:79], v250 offset:48416
    v_xor_b32 v220, v224, v220
    v_xor_b32 v222, v225, v222
    v_mfma_f32_16x16x32_bf16 v[164:167], a[140:143], a[4:7], v[164:167]
    s_nop 0
    v_mfma_f32_16x16x32_bf16 v[64:67], v[100:103], v[220:223], 0
    v_mfma_f32_16x16x32_bf16 v[72:75], v[104:107], v[220:223], 0
    buffer_load_dwordx4 v241, s[24:27], s53 offen offset:3072 lds
    v_mfma_f32_16x16x32_bf16 v[76:79], v[108:111], v[220:223], 0
    v_mfma_f32_16x16x32_bf16 v[48:51], v[112:115], v[220:223], 0
    v_mfma_f32_16x16x32_bf16 v[56:59], v[116:119], v[220:223], 0
    v_mfma_f32_16x16x32_bf16 v[60:63], v[100:103], v[216:219], 0
    v_mfma_f32_16x16x32_bf16 v[68:71], v[104:107], v[216:219], 0
    s_add_u32 m0, s81, 40960
    v_mfma_f32_16x16x32_bf16 v[40:43], v[108:111], v[216:219], 0
    buffer_load_dwordx4 v242, s[24:27], s53 offen offset:0 lds
    v_mfma_f32_16x16x32_bf16 v[44:47], v[112:115], v[216:219], 0
    v_mfma_f32_16x16x32_bf16 v[52:55], v[116:119], v[216:219], 0
    s_waitcnt vmcnt(9) lgkmcnt(0)
    s_barrier
    v_mfma_f32_16x16x32_bf16 v[24:27], v[80:83], v[212:215], 0
    ds_read_b128 a[128:131], v243 offset:0
    v_mfma_f32_16x16x32_bf16 v[32:35], v[84:87], v[212:215], 0
    ds_read_b128 a[132:135], v244 offset:0
    v_mfma_f32_16x16x32_bf16 v[36:39], v[88:91], v[212:215], 0
    ds_read_b128 a[136:139], v243 offset:2048
    s_add_u32 m0, s79, 73728
    v_mfma_f32_16x16x32_bf16 v[8:11], v[92:95], v[212:215], 0
    buffer_load_dwordx4 v234, s[16:19], s43 offen offset:0 lds
    v_mfma_f32_16x16x32_bf16 v[16:19], v[96:99], v[212:215], 0
    ds_read_b128 a[140:143], v244 offset:2048
    v_mfma_f32_16x16x32_bf16 v[20:23], v[80:83], v[208:211], 0
    ds_read_b128 a[144:147], v243 offset:4096
    v_mfma_f32_16x16x32_bf16 v[28:31], v[84:87], v[208:211], 0
    ds_read_b128 a[148:151], v244 offset:4096
    v_mfma_f32_16x16x32_bf16 v[0:3], v[88:91], v[208:211], 0
    ds_read_b128 a[152:155], v243 offset:6144
    v_mfma_f32_16x16x32_bf16 v[4:7], v[92:95], v[208:211], 0
    ds_read_b128 a[156:159], v244 offset:6144
    v_mfma_f32_16x16x32_bf16 v[12:15], v[96:99], v[208:211], 0
    buffer_load_dwordx4 v235, s[16:19], s43 offen offset:1024 lds
    v_mfma_f32_16x16x32_bf16 v[168:171], a[24:27], a[40:43], v[168:171]
    ds_read_b64_tr_b16 a[160:161], v247 offset:128
    v_mfma_f32_16x16x32_bf16 v[168:171], a[28:31], a[44:47], v[168:171]
    ds_read_b64_tr_b16 a[162:163], v247 offset:1408
    v_mfma_f32_16x16x32_bf16 v[172:175], a[32:35], a[40:43], v[172:175]
    ds_read_b64_tr_b16 a[164:165], v247 offset:10368
    v_mfma_f32_16x16x32_bf16 v[172:175], a[36:39], a[44:47], v[172:175]
    ds_read_b64_tr_b16 a[166:167], v247 offset:11648
    v_mfma_f32_16x16x32_bf16 v[176:179], a[24:27], a[48:51], v[176:179]
    buffer_load_dwordx4 v236, s[16:19], s43 offen offset:2048 lds
    v_mfma_f32_16x16x32_bf16 v[176:179], a[28:31], a[52:55], v[176:179]
    ds_read_b64_tr_b16 a[168:169], v248 offset:160
    v_cvt_pk_bf16_f32 v100, v168, v169
    v_mfma_f32_16x16x32_bf16 v[180:183], a[32:35], a[48:51], v[180:183]
    ds_read_b64_tr_b16 a[170:171], v248 offset:1440
    v_cvt_pk_bf16_f32 v101, v170, v171
    v_mfma_f32_16x16x32_bf16 v[180:183], a[36:39], a[52:55], v[180:183]
    ds_read_b64_tr_b16 a[172:173], v248 offset:10400
    v_cvt_pk_bf16_f32 v102, v172, v173
    v_mfma_f32_16x16x32_bf16 v[184:187], a[24:27], a[56:59], v[184:187]
    ds_read_b64_tr_b16 a[174:175], v248 offset:11680
    v_cvt_pk_bf16_f32 v103, v174, v175
    v_mfma_f32_16x16x32_bf16 v[184:187], a[28:31], a[60:63], v[184:187]
    ds_read_b64_tr_b16 a[176:177], v229 offset:0
    v_cvt_pk_bf16_f32 v104, v176, v177
    v_mfma_f32_16x16x32_bf16 v[188:191], a[32:35], a[56:59], v[188:191]
    buffer_load_dwordx4 v237, s[16:19], s43 offen offset:3072 lds
    v_mfma_f32_16x16x32_bf16 v[188:191], a[36:39], a[60:63], v[188:191]
    ds_read_b64_tr_b16 a[178:179], v229 offset:1280
    v_cvt_pk_bf16_f32 v105, v178, v179
    v_mfma_f32_16x16x32_bf16 v[192:195], a[24:27], a[64:67], v[192:195]
    ds_read_b64_tr_b16 a[180:181], v229 offset:10240
    v_cvt_pk_bf16_f32 v106, v180, v181
    v_mfma_f32_16x16x32_bf16 v[192:195], a[28:31], a[68:71], v[192:195]
    ds_read_b64_tr_b16 a[182:183], v229 offset:11520
    v_cvt_pk_bf16_f32 v107, v182, v183
    v_mfma_f32_16x16x32_bf16 v[196:199], a[32:35], a[64:67], v[196:199]
    ds_read_b64_tr_b16 a[184:185], v247 offset:0
    s_add_u32 m0, s81, 73728
    v_mfma_f32_16x16x32_bf16 v[196:199], a[36:39], a[68:71], v[196:199]
    buffer_load_dwordx4 v238, s[24:27], s54 offen offset:0 lds
    v_mfma_f32_16x16x32_bf16 v[200:203], a[24:27], a[72:75], v[200:203]
    ds_read_b64_tr_b16 a[186:187], v247 offset:1280
    v_cvt_pk_bf16_f32 v108, v184, v185
    v_mfma_f32_16x16x32_bf16 v[200:203], a[28:31], a[76:79], v[200:203]
    ds_read_b64_tr_b16 a[188:189], v247 offset:10240
    v_cvt_pk_bf16_f32 v109, v186, v187
    v_mfma_f32_16x16x32_bf16 v[204:207], a[32:35], a[72:75], v[204:207]
    ds_read_b64_tr_b16 a[190:191], v247 offset:11520
    v_cvt_pk_bf16_f32 v110, v188, v189
    v_mfma_f32_16x16x32_bf16 v[204:207], a[36:39], a[76:79], v[204:207]
    ds_read_b64_tr_b16 a[0:1], v248 offset:32
    v_cvt_pk_bf16_f32 v111, v190, v191
    v_mfma_f32_16x16x32_bf16 v[128:131], a[8:11], a[40:43], v[128:131]
    buffer_load_dwordx4 v239, s[24:27], s54 offen offset:1024 lds
    v_mfma_f32_16x16x32_bf16 v[128:131], a[12:15], a[44:47], v[128:131]
    ds_read_b64_tr_b16 a[2:3], v248 offset:1312
    v_cvt_pk_bf16_f32 v112, v192, v193
    v_mfma_f32_16x16x32_bf16 v[132:135], a[16:19], a[40:43], v[132:135]
    ds_read_b64_tr_b16 a[4:5], v248 offset:10272
    v_cvt_pk_bf16_f32 v113, v194, v195
    v_mfma_f32_16x16x32_bf16 v[132:135], a[20:23], a[44:47], v[132:135]
    ds_read_b64_tr_b16 a[6:7], v248 offset:11552
    v_cvt_pk_bf16_f32 v114, v196, v197
    v_mfma_f32_16x16x32_bf16 v[136:139], a[8:11], a[48:51], v[136:139]
    v_cvt_pk_bf16_f32 v115, v198, v199
    v_cvt_pk_bf16_f32 v116, v200, v201
    v_mfma_f32_16x16x32_bf16 v[136:139], a[12:15], a[52:55], v[136:139]
    v_cvt_pk_bf16_f32 v117, v202, v203
    v_cvt_pk_bf16_f32 v118, v204, v205
    v_mfma_f32_16x16x32_bf16 v[140:143], a[16:19], a[48:51], v[140:143]
    buffer_load_dwordx4 v240, s[24:27], s54 offen offset:2048 lds
    v_mfma_f32_16x16x32_bf16 v[140:143], a[20:23], a[52:55], v[140:143]
    v_cvt_pk_bf16_f32 v119, v206, v207
    v_cvt_pk_bf16_f32 v80, v128, v129
    v_mfma_f32_16x16x32_bf16 v[144:147], a[8:11], a[56:59], v[144:147]
    v_cvt_pk_bf16_f32 v81, v130, v131
    v_cvt_pk_bf16_f32 v82, v132, v133
    v_mfma_f32_16x16x32_bf16 v[144:147], a[12:15], a[60:63], v[144:147]
    v_cvt_pk_bf16_f32 v83, v134, v135
    v_cvt_pk_bf16_f32 v84, v136, v137
    v_mfma_f32_16x16x32_bf16 v[148:151], a[16:19], a[56:59], v[148:151]
    v_cvt_pk_bf16_f32 v85, v138, v139
    v_mfma_f32_16x16x32_bf16 v[148:151], a[20:23], a[60:63], v[148:151]
    buffer_load_dwordx4 v241, s[24:27], s54 offen offset:3072 lds
    v_mfma_f32_16x16x32_bf16 v[152:155], a[8:11], a[64:67], v[152:155]
    v_cvt_pk_bf16_f32 v86, v140, v141
    v_cvt_pk_bf16_f32 v87, v142, v143
    v_mfma_f32_16x16x32_bf16 v[152:155], a[12:15], a[68:71], v[152:155]
    v_cvt_pk_bf16_f32 v88, v144, v145
    v_cvt_pk_bf16_f32 v89, v146, v147
    v_mfma_f32_16x16x32_bf16 v[156:159], a[16:19], a[64:67], v[156:159]
    v_mfma_f32_16x16x32_bf16 v[156:159], a[20:23], a[68:71], v[156:159]
    v_cvt_pk_bf16_f32 v90, v148, v149
    v_cvt_pk_bf16_f32 v91, v150, v151
    v_mfma_f32_16x16x32_bf16 v[160:163], a[8:11], a[72:75], v[160:163]
    s_add_u32 m0, s81, 77824
    v_mfma_f32_16x16x32_bf16 v[160:163], a[12:15], a[76:79], v[160:163]
    buffer_load_dwordx4 v242, s[24:27], s54 offen offset:0 lds
    v_mfma_f32_16x16x32_bf16 v[164:167], a[16:19], a[72:75], v[164:167]
    v_cvt_pk_bf16_f32 v92, v152, v153
    v_cvt_pk_bf16_f32 v93, v154, v155
    v_mfma_f32_16x16x32_bf16 v[164:167], a[20:23], a[76:79], v[164:167]
    v_cvt_pk_bf16_f32 v94, v156, v157
    v_cvt_pk_bf16_f32 v95, v158, v159
    s_waitcnt vmcnt(9) lgkmcnt(0)
    s_barrier
    v_mfma_f32_16x16x32_bf16 v[168:171], a[144:147], a[160:163], 0
    ds_read_b128 v[208:211], v251 offset:8192
    v_cvt_pk_bf16_f32 v96, v160, v161
    v_mfma_f32_16x16x32_bf16 v[168:171], a[148:151], a[164:167], v[168:171]
    ds_read_b128 v[212:215], v251 offset:9216
    s_add_u32 s90, s92, s42
    v_mfma_f32_16x16x32_bf16 v[172:175], a[152:155], a[160:163], 0
    ds_read_b128 v[216:219], v251 offset:10240
    s_add_u32 m0, s83, 0
    v_mfma_f32_16x16x32_bf16 v[172:175], a[156:159], a[164:167], v[172:175]
    buffer_load_dwordx4 v232, s[36:39], s90 offen offset:0 sc1 lds
    v_mfma_f32_16x16x32_bf16 v[176:179], a[144:147], a[168:171], 0
    ds_read_b128 v[220:223], v251 offset:11264
    v_cvt_pk_bf16_f32 v97, v162, v163
    v_mfma_f32_16x16x32_bf16 v[176:179], a[148:151], a[172:175], v[176:179]
    ds_read_b128 a[8:11], v243 offset:36864
    v_cvt_pk_bf16_f32 v98, v164, v165
    v_mfma_f32_16x16x32_bf16 v[180:183], a[152:155], a[168:171], 0
    ds_read_b128 a[12:15], v244 offset:36864
    v_cvt_pk_bf16_f32 v99, v166, v167
    v_mfma_f32_16x16x32_bf16 v[180:183], a[156:159], a[172:175], v[180:183]
    buffer_load_dwordx4 v232, s[36:39], s90 offen offset:1024 sc1 lds
    v_mfma_f32_16x16x32_bf16 v[184:187], a[144:147], a[176:179], 0
    ds_read_b128 a[16:19], v243 offset:38912
    v_mfma_f32_16x16x32_bf16 v[184:187], a[148:151], a[180:183], v[184:187]
    ds_read_b128 a[20:23], v244 offset:38912
    s_waitcnt lgkmcnt(4)
    v_mfma_f32_16x16x32_bf16 v[188:191], a[152:155], a[176:179], 0
    ds_read_b128 a[24:27], v243 offset:40960
    s_add_u32 m0, s79, 110464
    v_mfma_f32_16x16x32_bf16 v[188:191], a[156:159], a[180:183], v[188:191]
    buffer_load_dwordx4 v234, s[16:19], s43 offen offset:128 lds
    v_mfma_f32_16x16x32_bf16 v[192:195], a[144:147], a[184:187], 0
    ds_read_b128 a[28:31], v244 offset:40960
    v_xor_b32 v208, v224, v208
    v_mfma_f32_16x16x32_bf16 v[192:195], a[148:151], a[188:191], v[192:195]
    ds_read_b128 a[32:35], v243 offset:43008
    v_xor_b32 v210, v225, v210
    v_mfma_f32_16x16x32_bf16 v[196:199], a[152:155], a[184:187], 0
    ds_read_b128 a[36:39], v244 offset:43008
    v_xor_b32 v212, v224, v212
    v_mfma_f32_16x16x32_bf16 v[196:199], a[156:159], a[188:191], v[196:199]
    buffer_load_dwordx4 v235, s[16:19], s43 offen offset:1152 lds
    v_mfma_f32_16x16x32_bf16 v[200:203], a[144:147], a[0:3], 0
    ds_read_b64_tr_b16 a[40:41], v247 offset:36992
    v_xor_b32 v214, v225, v214
    v_mfma_f32_16x16x32_bf16 v[200:203], a[148:151], a[4:7], v[200:203]
    ds_read_b64_tr_b16 a[42:43], v247 offset:38272
    v_xor_b32 v216, v224, v216
    v_mfma_f32_16x16x32_bf16 v[204:207], a[152:155], a[0:3], 0
    ds_read_b64_tr_b16 a[44:45], v247 offset:47232
    v_xor_b32 v218, v225, v218
    v_mfma_f32_16x16x32_bf16 v[204:207], a[156:159], a[4:7], v[204:207]
    buffer_load_dwordx4 v236, s[16:19], s43 offen offset:2176 lds
    v_mfma_f32_16x16x32_bf16 v[128:131], a[128:131], a[160:163], 0
    ds_read_b64_tr_b16 a[46:47], v247 offset:48512
    v_xor_b32 v220, v224, v220
    v_mfma_f32_16x16x32_bf16 v[128:131], a[132:135], a[164:167], v[128:131]
    ds_read_b64_tr_b16 a[48:49], v248 offset:37024
    v_xor_b32 v222, v225, v222
    v_mfma_f32_16x16x32_bf16 v[132:135], a[136:139], a[160:163], 0
    ds_read_b64_tr_b16 a[50:51], v248 offset:38304
    v_mfma_f32_16x16x32_bf16 v[132:135], a[140:143], a[164:167], v[132:135]
    buffer_load_dwordx4 v237, s[16:19], s43 offen offset:3200 lds
    v_mfma_f32_16x16x32_bf16 v[136:139], a[128:131], a[168:171], 0
    ds_read_b64_tr_b16 a[52:53], v248 offset:47264
    v_mfma_f32_16x16x32_bf16 v[136:139], a[132:135], a[172:175], v[136:139]
    ds_read_b64_tr_b16 a[54:55], v248 offset:48544
    v_mfma_f32_16x16x32_bf16 v[140:143], a[136:139], a[168:171], 0
    ds_read_b64_tr_b16 a[56:57], v229 offset:36864
    s_add_u32 m0, s81, 110592
    v_mfma_f32_16x16x32_bf16 v[140:143], a[140:143], a[172:175], v[140:143]
    buffer_load_dwordx4 v238, s[24:27], s55 offen offset:0 lds
    v_mfma_f32_16x16x32_bf16 v[144:147], a[128:131], a[176:179], 0
    ds_read_b64_tr_b16 a[58:59], v229 offset:38144
    v_mfma_f32_16x16x32_bf16 v[144:147], a[132:135], a[180:183], v[144:147]
    ds_read_b64_tr_b16 a[60:61], v229 offset:47104
    v_mfma_f32_16x16x32_bf16 v[148:151], a[136:139], a[176:179], 0
    ds_read_b64_tr_b16 a[62:63], v229 offset:48384
    v_mfma_f32_16x16x32_bf16 v[148:151], a[140:143], a[180:183], v[148:151]
    buffer_load_dwordx4 v239, s[24:27], s55 offen offset:1024 lds
    v_mfma_f32_16x16x32_bf16 v[152:155], a[128:131], a[184:187], 0
    ds_read_b64_tr_b16 a[64:65], v247 offset:36864
    v_mfma_f32_16x16x32_bf16 v[152:155], a[132:135], a[188:191], v[152:155]
    ds_read_b64_tr_b16 a[66:67], v247 offset:38144
    v_mfma_f32_16x16x32_bf16 v[156:159], a[136:139], a[184:187], 0
    ds_read_b64_tr_b16 a[68:69], v247 offset:47104
    v_mfma_f32_16x16x32_bf16 v[156:159], a[140:143], a[188:191], v[156:159]
    buffer_load_dwordx4 v240, s[24:27], s55 offen offset:2048 lds
    v_mfma_f32_16x16x32_bf16 v[160:163], a[128:131], a[0:3], 0
    ds_read_b64_tr_b16 a[70:71], v247 offset:48384
    v_mfma_f32_16x16x32_bf16 v[160:163], a[132:135], a[4:7], v[160:163]
    ds_read_b64_tr_b16 a[72:73], v248 offset:36896
    v_mfma_f32_16x16x32_bf16 v[164:167], a[136:139], a[0:3], 0
    ds_read_b64_tr_b16 a[74:75], v248 offset:38176
    v_mfma_f32_16x16x32_bf16 v[164:167], a[140:143], a[4:7], v[164:167]
    buffer_load_dwordx4 v241, s[24:27], s55 offen offset:3072 lds
    v_mfma_f32_16x16x32_bf16 v[64:67], v[100:103], v[220:223], v[64:67]
    ds_read_b64_tr_b16 a[76:77], v248 offset:47136
    v_mfma_f32_16x16x32_bf16 v[72:75], v[104:107], v[220:223], v[72:75]
    ds_read_b64_tr_b16 a[78:79], v248 offset:48416
    v_mfma_f32_16x16x32_bf16 v[76:79], v[108:111], v[220:223], v[76:79]
    s_add_u32 m0, s81, 114688
    v_mfma_f32_16x16x32_bf16 v[48:51], v[112:115], v[220:223], v[48:51]
    buffer_load_dwordx4 v242, s[24:27], s55 offen offset:0 lds
    v_mfma_f32_16x16x32_bf16 v[56:59], v[116:119], v[220:223], v[56:59]
    v_mfma_f32_16x16x32_bf16 v[60:63], v[100:103], v[216:219], v[60:63]
    v_mfma_f32_16x16x32_bf16 v[68:71], v[104:107], v[216:219], v[68:71]
    s_add_u32 m0, s79, 0
    v_mfma_f32_16x16x32_bf16 v[40:43], v[108:111], v[216:219], v[40:43]
    buffer_load_dwordx4 v234, s[16:19], s44 offen offset:0 lds
    v_mfma_f32_16x16x32_bf16 v[44:47], v[112:115], v[216:219], v[44:47]
    v_mfma_f32_16x16x32_bf16 v[52:55], v[116:119], v[216:219], v[52:55]
    s_waitcnt vmcnt(12) lgkmcnt(0)
    s_barrier
    v_mfma_f32_16x16x32_bf16 v[24:27], v[80:83], v[212:215], v[24:27]
    ds_read_b128 a[128:131], v245 offset:0
    v_mfma_f32_16x16x32_bf16 v[32:35], v[84:87], v[212:215], v[32:35]
    ds_read_b128 a[132:135], v246 offset:0
    v_mfma_f32_16x16x32_bf16 v[36:39], v[88:91], v[212:215], v[36:39]
    ds_read_b128 a[136:139], v245 offset:2048
    v_mfma_f32_16x16x32_bf16 v[8:11], v[92:95], v[212:215], v[8:11]
    buffer_load_dwordx4 v235, s[16:19], s44 offen offset:1024 lds
    v_mfma_f32_16x16x32_bf16 v[16:19], v[96:99], v[212:215], v[16:19]
    ds_read_b128 a[140:143], v246 offset:2048
    v_mfma_f32_16x16x32_bf16 v[20:23], v[80:83], v[208:211], v[20:23]
    ds_read_b128 a[144:147], v245 offset:4096
    v_mfma_f32_16x16x32_bf16 v[28:31], v[84:87], v[208:211], v[28:31]
    ds_read_b128 a[148:151], v246 offset:4096
    v_mfma_f32_16x16x32_bf16 v[0:3], v[88:91], v[208:211], v[0:3]
    ds_read_b128 a[152:155], v245 offset:6144
    v_mfma_f32_16x16x32_bf16 v[4:7], v[92:95], v[208:211], v[4:7]
    buffer_load_dwordx4 v236, s[16:19], s44 offen offset:2048 lds
    v_mfma_f32_16x16x32_bf16 v[12:15], v[96:99], v[208:211], v[12:15]
    ds_read_b128 a[156:159], v246 offset:6144
    v_mfma_f32_16x16x32_bf16 v[168:171], a[24:27], a[40:43], v[168:171]
    ds_read_b64_tr_b16 a[160:161], v249 offset:128
    v_mfma_f32_16x16x32_bf16 v[168:171], a[28:31], a[44:47], v[168:171]
    ds_read_b64_tr_b16 a[162:163], v249 offset:1408
    v_mfma_f32_16x16x32_bf16 v[172:175], a[32:35], a[40:43], v[172:175]
    ds_read_b64_tr_b16 a[164:165], v249 offset:10368
    v_mfma_f32_16x16x32_bf16 v[172:175], a[36:39], a[44:47], v[172:175]
    buffer_load_dwordx4 v237, s[16:19], s44 offen offset:3072 lds
    v_mfma_f32_16x16x32_bf16 v[176:179], a[24:27], a[48:51], v[176:179]
    ds_read_b64_tr_b16 a[166:167], v249 offset:11648
    v_mfma_f32_16x16x32_bf16 v[176:179], a[28:31], a[52:55], v[176:179]
    ds_read_b64_tr_b16 a[168:169], v250 offset:160
    v_cvt_pk_bf16_f32 v100, v168, v169
    v_mfma_f32_16x16x32_bf16 v[180:183], a[32:35], a[48:51], v[180:183]
    ds_read_b64_tr_b16 a[170:171], v250 offset:1440
    v_cvt_pk_bf16_f32 v101, v170, v171
    v_mfma_f32_16x16x32_bf16 v[180:183], a[36:39], a[52:55], v[180:183]
    ds_read_b64_tr_b16 a[172:173], v250 offset:10400
    s_add_u32 m0, s81, 0
    v_mfma_f32_16x16x32_bf16 v[184:187], a[24:27], a[56:59], v[184:187]
    buffer_load_dwordx4 v238, s[24:27], s56 offen offset:0 lds
    v_mfma_f32_16x16x32_bf16 v[184:187], a[28:31], a[60:63], v[184:187]
    ds_read_b64_tr_b16 a[174:175], v250 offset:11680
    v_cvt_pk_bf16_f32 v102, v172, v173
    v_mfma_f32_16x16x32_bf16 v[188:191], a[32:35], a[56:59], v[188:191]
    ds_read_b64_tr_b16 a[176:177], v253 offset:0
    v_cvt_pk_bf16_f32 v103, v174, v175
    v_mfma_f32_16x16x32_bf16 v[188:191], a[36:39], a[60:63], v[188:191]
    ds_read_b64_tr_b16 a[178:179], v253 offset:1280
    v_cvt_pk_bf16_f32 v104, v176, v177
    v_mfma_f32_16x16x32_bf16 v[192:195], a[24:27], a[64:67], v[192:195]
    ds_read_b64_tr_b16 a[180:181], v253 offset:10240
    v_cvt_pk_bf16_f32 v105, v178, v179
    v_mfma_f32_16x16x32_bf16 v[192:195], a[28:31], a[68:71], v[192:195]
    buffer_load_dwordx4 v239, s[24:27], s56 offen offset:1024 lds
    v_mfma_f32_16x16x32_bf16 v[196:199], a[32:35], a[64:67], v[196:199]
    ds_read_b64_tr_b16 a[182:183], v253 offset:11520
    v_cvt_pk_bf16_f32 v106, v180, v181
    v_mfma_f32_16x16x32_bf16 v[196:199], a[36:39], a[68:71], v[196:199]
    ds_read_b64_tr_b16 a[184:185], v249 offset:0
    v_cvt_pk_bf16_f32 v107, v182, v183
    v_mfma_f32_16x16x32_bf16 v[200:203], a[24:27], a[72:75], v[200:203]
    ds_read_b64_tr_b16 a[186:187], v249 offset:1280
    v_cvt_pk_bf16_f32 v108, v184, v185
    v_mfma_f32_16x16x32_bf16 v[200:203], a[28:31], a[76:79], v[200:203]
    buffer_load_dwordx4 v240, s[24:27], s56 offen offset:2048 lds
    v_mfma_f32_16x16x32_bf16 v[204:207], a[32:35], a[72:75], v[204:207]
    ds_read_b64_tr_b16 a[188:189], v249 offset:10240
    v_cvt_pk_bf16_f32 v109, v186, v187
    v_mfma_f32_16x16x32_bf16 v[204:207], a[36:39], a[76:79], v[204:207]
    ds_read_b64_tr_b16 a[190:191], v249 offset:11520
    v_cvt_pk_bf16_f32 v110, v188, v189
    v_mfma_f32_16x16x32_bf16 v[128:131], a[8:11], a[40:43], v[128:131]
    ds_read_b64_tr_b16 a[0:1], v250 offset:32
    v_cvt_pk_bf16_f32 v111, v190, v191
    v_mfma_f32_16x16x32_bf16 v[128:131], a[12:15], a[44:47], v[128:131]
    ds_read_b64_tr_b16 a[2:3], v250 offset:1312
    v_cvt_pk_bf16_f32 v112, v192, v193
    v_mfma_f32_16x16x32_bf16 v[132:135], a[16:19], a[40:43], v[132:135]
    buffer_load_dwordx4 v241, s[24:27], s56 offen offset:3072 lds
    v_mfma_f32_16x16x32_bf16 v[132:135], a[20:23], a[44:47], v[132:135]
    ds_read_b64_tr_b16 a[4:5], v250 offset:10272
    v_cvt_pk_bf16_f32 v113, v194, v195
    v_mfma_f32_16x16x32_bf16 v[136:139], a[8:11], a[48:51], v[136:139]
    ds_read_b64_tr_b16 a[6:7], v250 offset:11552
    v_cvt_pk_bf16_f32 v114, v196, v197
    v_mfma_f32_16x16x32_bf16 v[136:139], a[12:15], a[52:55], v[136:139]
    v_cvt_pk_bf16_f32 v115, v198, v199
    v_cvt_pk_bf16_f32 v116, v200, v201
    v_mfma_f32_16x16x32_bf16 v[140:143], a[16:19], a[48:51], v[140:143]
    s_add_u32 m0, s81, 4096
    v_cvt_pk_bf16_f32 v117, v202, v203
    v_mfma_f32_16x16x32_bf16 v[140:143], a[20:23], a[52:55], v[140:143]
    buffer_load_dwordx4 v242, s[24:27], s56 offen offset:0 lds
    v_mfma_f32_16x16x32_bf16 v[144:147], a[8:11], a[56:59], v[144:147]
    v_cvt_pk_bf16_f32 v118, v204, v205
    v_cvt_pk_bf16_f32 v119, v206, v207
    v_mfma_f32_16x16x32_bf16 v[144:147], a[12:15], a[60:63], v[144:147]
    v_cvt_pk_bf16_f32 v80, v128, v129
    v_cvt_pk_bf16_f32 v81, v130, v131
    v_mfma_f32_16x16x32_bf16 v[148:151], a[16:19], a[56:59], v[148:151]
    v_cvt_pk_bf16_f32 v82, v132, v133
    v_cvt_pk_bf16_f32 v83, v134, v135
    v_mfma_f32_16x16x32_bf16 v[148:151], a[20:23], a[60:63], v[148:151]
    s_add_u32 m0, s79, 36736
    v_cvt_pk_bf16_f32 v84, v136, v137
    v_mfma_f32_16x16x32_bf16 v[152:155], a[8:11], a[64:67], v[152:155]
    buffer_load_dwordx4 v234, s[16:19], s44 offen offset:128 lds
    v_mfma_f32_16x16x32_bf16 v[152:155], a[12:15], a[68:71], v[152:155]
    v_cvt_pk_bf16_f32 v85, v138, v139
    v_cvt_pk_bf16_f32 v86, v140, v141
    v_mfma_f32_16x16x32_bf16 v[156:159], a[16:19], a[64:67], v[156:159]
    v_cvt_pk_bf16_f32 v87, v142, v143
    v_cvt_pk_bf16_f32 v88, v144, v145
    v_mfma_f32_16x16x32_bf16 v[156:159], a[20:23], a[68:71], v[156:159]
    v_cvt_pk_bf16_f32 v89, v146, v147
    v_cvt_pk_bf16_f32 v90, v148, v149
    v_mfma_f32_16x16x32_bf16 v[160:163], a[8:11], a[72:75], v[160:163]
    v_cvt_pk_bf16_f32 v91, v150, v151
    v_mfma_f32_16x16x32_bf16 v[160:163], a[12:15], a[76:79], v[160:163]
    buffer_load_dwordx4 v235, s[16:19], s44 offen offset:1152 lds
    v_mfma_f32_16x16x32_bf16 v[164:167], a[16:19], a[72:75], v[164:167]
    v_cvt_pk_bf16_f32 v92, v152, v153
    v_cvt_pk_bf16_f32 v93, v154, v155
    v_mfma_f32_16x16x32_bf16 v[164:167], a[20:23], a[76:79], v[164:167]
    v_cvt_pk_bf16_f32 v94, v156, v157
    v_cvt_pk_bf16_f32 v95, v158, v159
    s_waitcnt vmcnt(11) lgkmcnt(0)
    s_barrier
    v_mfma_f32_16x16x32_bf16 v[168:171], a[144:147], a[160:163], 0
    ds_read_b128 v[208:211], v251 offset:0
    v_cvt_pk_bf16_f32 v96, v160, v161
    v_mfma_f32_16x16x32_bf16 v[168:171], a[148:151], a[164:167], v[168:171]
    ds_read_b128 v[212:215], v251 offset:1024
    s_add_u32 s90, s92, s43
    v_mfma_f32_16x16x32_bf16 v[172:175], a[152:155], a[160:163], 0
    ds_read_b128 v[216:219], v251 offset:2048
    s_add_u32 m0, s83, 8192
    v_mfma_f32_16x16x32_bf16 v[172:175], a[156:159], a[164:167], v[172:175]
    buffer_load_dwordx4 v232, s[36:39], s90 offen offset:0 sc1 lds
    v_mfma_f32_16x16x32_bf16 v[176:179], a[144:147], a[168:171], 0
    ds_read_b128 v[220:223], v251 offset:3072
    v_cvt_pk_bf16_f32 v97, v162, v163
    v_mfma_f32_16x16x32_bf16 v[176:179], a[148:151], a[172:175], v[176:179]
    ds_read_b128 a[8:11], v245 offset:36864
    v_cvt_pk_bf16_f32 v98, v164, v165
    v_mfma_f32_16x16x32_bf16 v[180:183], a[152:155], a[168:171], 0
    ds_read_b128 a[12:15], v246 offset:36864
    v_cvt_pk_bf16_f32 v99, v166, v167
    v_mfma_f32_16x16x32_bf16 v[180:183], a[156:159], a[172:175], v[180:183]
    buffer_load_dwordx4 v232, s[36:39], s90 offen offset:1024 sc1 lds
    v_mfma_f32_16x16x32_bf16 v[184:187], a[144:147], a[176:179], 0
    ds_read_b128 a[16:19], v245 offset:38912
    v_mfma_f32_16x16x32_bf16 v[184:187], a[148:151], a[180:183], v[184:187]
    ds_read_b128 a[20:23], v246 offset:38912
    s_waitcnt lgkmcnt(4)
    v_mfma_f32_16x16x32_bf16 v[188:191], a[152:155], a[176:179], 0
    ds_read_b128 a[24:27], v245 offset:40960
    s_add_u32 m0, s79, 36736
    v_mfma_f32_16x16x32_bf16 v[188:191], a[156:159], a[180:183], v[188:191]
    buffer_load_dwordx4 v236, s[16:19], s44 offen offset:2176 lds
    v_mfma_f32_16x16x32_bf16 v[192:195], a[144:147], a[184:187], 0
    ds_read_b128 a[28:31], v246 offset:40960
    v_xor_b32 v208, v224, v208
    v_mfma_f32_16x16x32_bf16 v[192:195], a[148:151], a[188:191], v[192:195]
    ds_read_b128 a[32:35], v245 offset:43008
    v_xor_b32 v210, v225, v210
    v_mfma_f32_16x16x32_bf16 v[196:199], a[152:155], a[184:187], 0
    ds_read_b128 a[36:39], v246 offset:43008
    v_or_b32 v252, v208, v210
    v_mfma_f32_16x16x32_bf16 v[196:199], a[156:159], a[188:191], v[196:199]
    buffer_load_dwordx4 v237, s[16:19], s44 offen offset:3200 lds
    v_mfma_f32_16x16x32_bf16 v[200:203], a[144:147], a[0:3], 0
    ds_read_b64_tr_b16 a[40:41], v249 offset:36992
    v_xor_b32 v212, v224, v212
    v_mfma_f32_16x16x32_bf16 v[200:203], a[148:151], a[4:7], v[200:203]
    ds_read_b64_tr_b16 a[42:43], v249 offset:38272
    v_xor_b32 v214, v225, v214
    v_mfma_f32_16x16x32_bf16 v[204:207], a[152:155], a[0:3], 0
    ds_read_b64_tr_b16 a[44:45], v249 offset:47232
    s_add_u32 m0, s81, 36864
    v_mfma_f32_16x16x32_bf16 v[204:207], a[156:159], a[4:7], v[204:207]
    buffer_load_dwordx4 v238, s[24:27], s57 offen offset:0 lds
    v_mfma_f32_16x16x32_bf16 v[128:131], a[128:131], a[160:163], 0
    ds_read_b64_tr_b16 a[46:47], v249 offset:48512
    v_or3_b32 v252, v252, v212, v214
    v_mfma_f32_16x16x32_bf16 v[128:131], a[132:135], a[164:167], v[128:131]
    ds_read_b64_tr_b16 a[48:49], v250 offset:37024
    v_xor_b32 v216, v224, v216
    v_mfma_f32_16x16x32_bf16 v[132:135], a[136:139], a[160:163], 0
    ds_read_b64_tr_b16 a[50:51], v250 offset:38304
    v_xor_b32 v218, v225, v218
    v_mfma_f32_16x16x32_bf16 v[132:135], a[140:143], a[164:167], v[132:135]
    buffer_load_dwordx4 v239, s[24:27], s57 offen offset:1024 lds
    v_mfma_f32_16x16x32_bf16 v[136:139], a[128:131], a[168:171], 0
    ds_read_b64_tr_b16 a[52:53], v250 offset:47264
    v_or3_b32 v252, v252, v216, v218
    v_mfma_f32_16x16x32_bf16 v[136:139], a[132:135], a[172:175], v[136:139]
    ds_read_b64_tr_b16 a[54:55], v250 offset:48544
    v_xor_b32 v220, v224, v220
    v_mfma_f32_16x16x32_bf16 v[140:143], a[136:139], a[168:171], 0
    ds_read_b64_tr_b16 a[56:57], v253 offset:36864
    v_xor_b32 v222, v225, v222
    v_mfma_f32_16x16x32_bf16 v[140:143], a[140:143], a[172:175], v[140:143]
    buffer_load_dwordx4 v240, s[24:27], s57 offen offset:2048 lds
    v_mfma_f32_16x16x32_bf16 v[144:147], a[128:131], a[176:179], 0
    ds_read_b64_tr_b16 a[58:59], v253 offset:38144
    v_or3_b32 v252, v252, v220, v222
    v_mfma_f32_16x16x32_bf16 v[144:147], a[132:135], a[180:183], v[144:147]
    ds_read_b64_tr_b16 a[60:61], v253 offset:47104
    v_and_b32 v252, 0xc000c000, v252
    v_mfma_f32_16x16x32_bf16 v[148:151], a[136:139], a[176:179], 0
    ds_read_b64_tr_b16 a[62:63], v253 offset:48384
    v_cmp_ne_u32 vcc, 0, v252
    v_mfma_f32_16x16x32_bf16 v[148:151], a[140:143], a[180:183], v[148:151]
    buffer_load_dwordx4 v241, s[24:27], s57 offen offset:3072 lds
    v_mfma_f32_16x16x32_bf16 v[152:155], a[128:131], a[184:187], 0
    ds_read_b64_tr_b16 a[64:65], v249 offset:36864
    s_cbranch_vccnz L_pslow2
L_pback2:
    v_mfma_f32_16x16x32_bf16 v[152:155], a[132:135], a[188:191], v[152:155]
    ds_read_b64_tr_b16 a[66:67], v249 offset:38144
    v_mfma_f32_16x16x32_bf16 v[156:159], a[136:139], a[184:187], 0
    ds_read_b64_tr_b16 a[68:69], v249 offset:47104
    s_add_u32 m0, s81, 40960
    v_mfma_f32_16x16x32_bf16 v[156:159], a[140:143], a[188:191], v[156:159]
    buffer_load_dwordx4 v242, s[24:27], s57 offen offset:0 lds
    v_mfma_f32_16x16x32_bf16 v[160:163], a[128:131], a[0:3], 0
    ds_read_b64_tr_b16 a[70:71], v249 offset:48384
    v_mfma_f32_16x16x32_bf16 v[160:163], a[132:135], a[4:7], v[160:163]
    ds_read_b64_tr_b16 a[72:73], v250 offset:36896
    v_mfma_f32_16x16x32_bf16 v[164:167], a[136:139], a[0:3], 0
    ds_read_b64_tr_b16 a[74:75], v250 offset:38176
    s_add_u32 m0, s79, 73728
    v_mfma_f32_16x16x32_bf16 v[164:167], a[140:143], a[4:7], v[164:167]
    buffer_load_dwordx4 v234, s[16:19], s45 offen offset:0 lds
    v_mfma_f32_16x16x32_bf16 v[64:67], v[100:103], v[220:223], v[64:67]
    ds_read_b64_tr_b16 a[76:77], v250 offset:47136
    v_mfma_f32_16x16x32_bf16 v[72:75], v[104:107], v[220:223], v[72:75]
    ds_read_b64_tr_b16 a[78:79], v250 offset:48416
    v_mfma_f32_16x16x32_bf16 v[76:79], v[108:111], v[220:223], v[76:79]
    v_mfma_f32_16x16x32_bf16 v[48:51], v[112:115], v[220:223], v[48:51]
    buffer_load_dwordx4 v235, s[16:19], s45 offen offset:1024 lds
    v_mfma_f32_16x16x32_bf16 v[56:59], v[116:119], v[220:223], v[56:59]
    v_mfma_f32_16x16x32_bf16 v[60:63], v[100:103], v[216:219], v[60:63]
    v_mfma_f32_16x16x32_bf16 v[68:71], v[104:107], v[216:219], v[68:71]
    v_mfma_f32_16x16x32_bf16 v[40:43], v[108:111], v[216:219], v[40:43]
    buffer_load_dwordx4 v236, s[16:19], s45 offen offset:2048 lds
    v_mfma_f32_16x16x32_bf16 v[44:47], v[112:115], v[216:219], v[44:47]
    v_mfma_f32_16x16x32_bf16 v[52:55], v[116:119], v[216:219], v[52:55]
    s_waitcnt vmcnt(14) lgkmcnt(0)
    s_barrier
    v_mfma_f32_16x16x32_bf16 v[24:27], v[80:83], v[212:215], v[24:27]
    ds_read_b128 a[128:131], v243 offset:0
    v_mfma_f32_16x16x32_bf16 v[32:35], v[84:87], v[212:215], v[32:35]
    ds_read_b128 a[132:135], v244 offset:0
    v_mfma_f32_16x16x32_bf16 v[36:39], v[88:91], v[212:215], v[36:39]
    ds_read_b128 a[136:139], v243 offset:2048
    v_mfma_f32_16x16x32_bf16 v[8:11], v[92:95], v[212:215], v[8:11]
    buffer_load_dwordx4 v237, s[16:19], s45 offen offset:3072 lds
    v_mfma_f32_16x16x32_bf16 v[16:19], v[96:99], v[212:215], v[16:19]
    ds_read_b128 a[140:143], v244 offset:2048
    v_mfma_f32_16x16x32_bf16 v[20:23], v[80:83], v[208:211], v[20:23]
    ds_read_b128 a[144:147], v243 offset:4096
L_pad5:
    s_cbranch_execz L_hop2
    v_mfma_f32_16x16x32_bf16 v[28:31], v[84:87], v[208:211], v[28:31]
    ds_read_b128 a[148:151], v244 offset:4096
    v_mfma_f32_16x16x32_bf16 v[0:3], v[88:91], v[208:211], v[0:3]
    ds_read_b128 a[152:155], v243 offset:6144
    s_add_u32 m0, s81, 73728
    v_mfma_f32_16x16x32_bf16 v[4:7], v[92:95], v[208:211], v[4:7]
    buffer_load_dwordx4 v238, s[24:27], s58 offen offset:0 lds
    v_mfma_f32_16x16x32_bf16 v[12:15], v[96:99], v[208:211], v[12:15]
    ds_read_b128 a[156:159], v244 offset:6144
    v_mfma_f32_16x16x32_bf16 v[168:171], a[24:27], a[40:43], v[168:171]
    ds_read_b64_tr_b16 a[160:161], v247 offset:128
    v_mfma_f32_16x16x32_bf16 v[168:171], a[28:31], a[44:47], v[168:171]
    ds_read_b64_tr_b16 a[162:163], v247 offset:1408
    v_mfma_f32_16x16x32_bf16 v[172:175], a[32:35], a[40:43], v[172:175]
    ds_read_b64_tr_b16 a[164:165], v247 offset:10368
    v_mfma_f32_16x16x32_bf16 v[172:175], a[36:39], a[44:47], v[172:175]
    buffer_load_dwordx4 v239, s[24:27], s58 offen offset:1024 lds
    v_mfma_f32_16x16x32_bf16 v[176:179], a[24:27], a[48:51], v[176:179]
    ds_read_b64_tr_b16 a[166:167], v247 offset:11648
    v_mfma_f32_16x16x32_bf16 v[176:179], a[28:31], a[52:55], v[176:179]
    ds_read_b64_tr_b16 a[168:169], v248 offset:160
    v_cvt_pk_bf16_f32 v100, v168, v169
    v_mfma_f32_16x16x32_bf16 v[180:183], a[32:35], a[48:51], v[180:183]
    ds_read_b64_tr_b16 a[170:171], v248 offset:1440
    v_cvt_pk_bf16_f32 v101, v170, v171
    v_mfma_f32_16x16x32_bf16 v[180:183], a[36:39], a[52:55], v[180:183]
    ds_read_b64_tr_b16 a[172:173], v248 offset:10400
    v_cvt_pk_bf16_f32 v102, v172, v173
    v_mfma_f32_16x16x32_bf16 v[184:187], a[24:27], a[56:59], v[184:187]
    buffer_load_dwordx4 v240, s[24:27], s58 offen offset:2048 lds
    v_mfma_f32_16x16x32_bf16 v[184:187], a[28:31], a[60:63], v[184:187]
    ds_read_b64_tr_b16 a[174:175], v248 offset:11680
    v_cvt_pk_bf16_f32 v103, v174, v175
    v_mfma_f32_16x16x32_bf16 v[188:191], a[32:35], a[56:59], v[188:191]
    ds_read_b64_tr_b16 a[176:177], v229 offset:0
    v_cvt_pk_bf16_f32 v104, v176, v177
    v_mfma_f32_16x16x32_bf16 v[188:191], a[36:39], a[60:63], v[188:191]
    ds_read_b64_tr_b16 a[178:179], v229 offset:1280
    v_cvt_pk_bf16_f32 v105, v178, v179
    v_mfma_f32_16x16x32_bf16 v[192:195], a[24:27], a[64:67], v[192:195]
    ds_read_b64_tr_b16 a[180:181], v229 offset:10240
    v_cvt_pk_bf16_f32 v106, v180, v181
    v_mfma_f32_16x16x32_bf16 v[192:195], a[28:31], a[68:71], v[192:195]
    buffer_load_dwordx4 v241, s[24:27], s58 offen offset:3072 lds
    v_mfma_f32_16x16x32_bf16 v[196:199], a[32:35], a[64:67], v[196:199]
    ds_read_b64_tr_b16 a[182:183], v229 offset:11520
    v_cvt_pk_bf16_f32 v107, v182, v183
    v_mfma_f32_16x16x32_bf16 v[196:199], a[36:39], a[68:71], v[196:199]
    ds_read_b64_tr_b16 a[184:185], v247 offset:0
    v_cvt_pk_bf16_f32 v108, v184, v185
    v_mfma_f32_16x16x32_bf16 v[200:203], a[24:27], a[72:75], v[200:203]
    ds_read_b64_tr_b16 a[186:187], v247 offset:1280
    s_add_u32 m0, s81, 77824
    v_mfma_f32_16x16x32_bf16 v[200:203], a[28:31], a[76:79], v[200:203]
    buffer_load_dwordx4 v242, s[24:27], s58 offen offset:0 lds
    v_mfma_f32_16x16x32_bf16 v[204:207], a[32:35], a[72:75], v[204:207]
    ds_read_b64_tr_b16 a[188:189], v247 offset:10240
    v_cvt_pk_bf16_f32 v109, v186, v187
    v_mfma_f32_16x16x32_bf16 v[204:207], a[36:39], a[76:79], v[204:207]
    ds_read_b64_tr_b16 a[190:191], v247 offset:11520
    v_cvt_pk_bf16_f32 v110, v188, v189
    v_mfma_f32_16x16x32_bf16 v[128:131], a[8:11], a[40:43], v[128:131]
    ds_read_b64_tr_b16 a[0:1], v248 offset:32
    v_cvt_pk_bf16_f32 v111, v190, v191
    v_mfma_f32_16x16x32_bf16 v[128:131], a[12:15], a[44:47], v[128:131]
    ds_read_b64_tr_b16 a[2:3], v248 offset:1312
    s_add_u32 m0, s79, 110464
    v_mfma_f32_16x16x32_bf16 v[132:135], a[16:19], a[40:43], v[132:135]
    buffer_load_dwordx4 v234, s[16:19], s45 offen offset:128 lds
    v_mfma_f32_16x16x32_bf16 v[132:135], a[20:23], a[44:47], v[132:135]
    ds_read_b64_tr_b16 a[4:5], v248 offset:10272
    v_cvt_pk_bf16_f32 v112, v192, v193
    v_mfma_f32_16x16x32_bf16 v[136:139], a[8:11], a[48:51], v[136:139]
    ds_read_b64_tr_b16 a[6:7], v248 offset:11552
    v_cvt_pk_bf16_f32 v113, v194, v195
    v_mfma_f32_16x16x32_bf16 v[136:139], a[12:15], a[52:55], v[136:139]
    v_cvt_pk_bf16_f32 v114, v196, v197
    v_cvt_pk_bf16_f32 v115, v198, v199
    v_mfma_f32_16x16x32_bf16 v[140:143], a[16:19], a[48:51], v[140:143]
    v_cvt_pk_bf16_f32 v116, v200, v201
    v_cvt_pk_bf16_f32 v117, v202, v203
    v_mfma_f32_16x16x32_bf16 v[140:143], a[20:23], a[52:55], v[140:143]
    buffer_load_dwordx4 v235, s[16:19], s45 offen offset:1152 lds
    v_mfma_f32_16x16x32_bf16 v[144:147], a[8:11], a[56:59], v[144:147]
    v_cvt_pk_bf16_f32 v118, v204, v205
    v_cvt_pk_bf16_f32 v119, v206, v207
    v_mfma_f32_16x16x32_bf16 v[144:147], a[12:15], a[60:63], v[144:147]
    v_cvt_pk_bf16_f32 v80, v128, v129
    v_cvt_pk_bf16_f32 v81, v130, v131
    v_mfma_f32_16x16x32_bf16 v[148:151], a[16:19], a[56:59], v[148:151]
    v_cvt_pk_bf16_f32 v82, v132, v133
    v_cvt_pk_bf16_f32 v83, v134, v135
    v_mfma_f32_16x16x32_bf16 v[148:151], a[20:23], a[60:63], v[148:151]
    v_cvt_pk_bf16_f32 v84, v136, v137
    v_cvt_pk_bf16_f32 v85, v138, v139
    v_mfma_f32_16x16x32_bf16 v[152:155], a[8:11], a[64:67], v[152:155]
    buffer_load_dwordx4 v236, s[16:19], s45 offen offset:2176 lds
    v_mfma_f32_16x16x32_bf16 v[152:155], a[12:15], a[68:71], v[152:155]
    v_cvt_pk_bf16_f32 v86, v140, v141
    v_cvt_pk_bf16_f32 v87, v142, v143
    v_mfma_f32_16x16x32_bf16 v[156:159], a[16:19], a[64:67], v[156:159]
    v_cvt_pk_bf16_f32 v88, v144, v145
    v_cvt_pk_bf16_f32 v89, v146, v147
    v_mfma_f32_16x16x32_bf16 v[156:159], a[20:23], a[68:71], v[156:159]
    v_cvt_pk_bf16_f32 v90, v148, v149
    v_cvt_pk_bf16_f32 v91, v150, v151
    v_mfma_f32_16x16x32_bf16 v[160:163], a[8:11], a[72:75], v[160:163]
    v_mfma_f32_16x16x32_bf16 v[160:163], a[12:15], a[76:79], v[160:163]
    buffer_load_dwordx4 v237, s[16:19], s45 offen offset:3200 lds
    v_mfma_f32_16x16x32_bf16 v[164:167], a[16:19], a[72:75], v[164:167]
    v_cvt_pk_bf16_f32 v92, v152, v153
    v_cvt_pk_bf16_f32 v93, v154, v155
    v_mfma_f32_16x16x32_bf16 v[164:167], a[20:23], a[76:79], v[164:167]
    v_cvt_pk_bf16_f32 v94, v156, v157
    v_cvt_pk_bf16_f32 v95, v158, v159
    s_waitcnt vmcnt(13) lgkmcnt(0)
    s_barrier
    v_mfma_f32_16x16x32_bf16 v[168:171], a[144:147], a[160:163], 0
    ds_read_b128 v[208:211], v251 offset:8192
    v_cvt_pk_bf16_f32 v96, v160, v161
    v_mfma_f32_16x16x32_bf16 v[168:171], a[148:151], a[164:167], v[168:171]
    ds_read_b128 v[212:215], v251 offset:9216
    s_add_u32 s90, s92, s44
    v_mfma_f32_16x16x32_bf16 v[172:175], a[152:155], a[160:163], 0
    ds_read_b128 v[216:219], v251 offset:10240
    s_add_u32 m0, s83, 0
    v_mfma_f32_16x16x32_bf16 v[172:175], a[156:159], a[164:167], v[172:175]
    buffer_load_dwordx4 v232, s[36:39], s90 offen offset:0 sc1 lds
    v_mfma_f32_16x16x32_bf16 v[176:179], a[144:147], a[168:171], 0
    ds_read_b128 v[220:223], v251 offset:11264
    v_cvt_pk_bf16_f32 v97, v162, v163
    v_mfma_f32_16x16x32_bf16 v[176:179], a[148:151], a[172:175], v[176:179]
    ds_read_b128 a[8:11], v243 offset:36864
    v_cvt_pk_bf16_f32 v98, v164, v165
    v_mfma_f32_16x16x32_bf16 v[180:183], a[152:155], a[168:171], 0
    ds_read_b128 a[12:15], v244 offset:36864
    v_cvt_pk_bf16_f32 v99, v166, v167
    v_mfma_f32_16x16x32_bf16 v[180:183], a[156:159], a[172:175], v[180:183]
    buffer_load_dwordx4 v232, s[36:39], s90 offen offset:1024 sc1 lds
    v_mfma_f32_16x16x32_bf16 v[184:187], a[144:147], a[176:179], 0
    ds_read_b128 a[16:19], v243 offset:38912
    v_mfma_f32_16x16x32_bf16 v[184:187], a[148:151], a[180:183], v[184:187]
    ds_read_b128 a[20:23], v244 offset:38912
    s_waitcnt lgkmcnt(4)
    v_mfma_f32_16x16x32_bf16 v[188:191], a[152:155], a[176:179], 0
    ds_read_b128 a[24:27], v243 offset:40960
    s_add_u32 m0, s81, 110592
    v_mfma_f32_16x16x32_bf16 v[188:191], a[156:159], a[180:183], v[188:191]
    buffer_load_dwordx4 v238, s[24:27], s59 offen offset:0 lds
    v_mfma_f32_16x16x32_bf16 v[192:195], a[144:147], a[184:187], 0
    ds_read_b128 a[28:31], v244 offset:40960
    v_xor_b32 v208, v224, v208
    v_mfma_f32_16x16x32_bf16 v[192:195], a[148:151], a[188:191], v[192:195]
    ds_read_b128 a[32:35], v243 offset:43008
    v_xor_b32 v210, v225, v210
    v_mfma_f32_16x16x32_bf16 v[196:199], a[152:155], a[184:187], 0
    ds_read_b128 a[36:39], v244 offset:43008
    v_or_b32 v252, v208, v210
    v_mfma_f32_16x16x32_bf16 v[196:199], a[156:159], a[188:191], v[196:199]
    buffer_load_dwordx4 v239, s[24:27], s59 offen offset:1024 lds
    v_mfma_f32_16x16x32_bf16 v[200:203], a[144:147], a[0:3], 0
    ds_read_b64_tr_b16 a[40:41], v247 offset:36992
    v_xor_b32 v212, v224, v212
    v_mfma_f32_16x16x32_bf16 v[200:203], a[148:151], a[4:7], v[200:203]
    ds_read_b64_tr_b16 a[42:43], v247 offset:38272
    v_xor_b32 v214, v225, v214
    v_mfma_f32_16x16x32_bf16 v[204:207], a[152:155], a[0:3], 0
    ds_read_b64_tr_b16 a[44:45], v247 offset:47232
    v_or3_b32 v252, v252, v212, v214
    v_mfma_f32_16x16x32_bf16 v[204:207], a[156:159], a[4:7], v[204:207]
    buffer_load_dwordx4 v240, s[24:27], s59 offen offset:2048 lds
    v_mfma_f32_16x16x32_bf16 v[128:131], a[128:131], a[160:163], 0
    ds_read_b64_tr_b16 a[46:47], v247 offset:48512
    v_xor_b32 v216, v224, v216
    v_mfma_f32_16x16x32_bf16 v[128:131], a[132:135], a[164:167], v[128:131]
    ds_read_b64_tr_b16 a[48:49], v248 offset:37024
    v_xor_b32 v218, v225, v218
    v_mfma_f32_16x16x32_bf16 v[132:135], a[136:139], a[160:163], 0
    ds_read_b64_tr_b16 a[50:51], v248 offset:38304
    v_or3_b32 v252, v252, v216, v218
    v_mfma_f32_16x16x32_bf16 v[132:135], a[140:143], a[164:167], v[132:135]
    buffer_load_dwordx4 v241, s[24:27], s59 offen offset:3072 lds
    v_mfma_f32_16x16x32_bf16 v[136:139], a[128:131], a[168:171], 0
    ds_read_b64_tr_b16 a[52:53], v248 offset:47264
    v_xor_b32 v220, v224, v220
    v_mfma_f32_16x16x32_bf16 v[136:139], a[132:135], a[172:175], v[136:139]
    ds_read_b64_tr_b16 a[54:55], v248 offset:48544
    v_xor_b32 v222, v225, v222
    v_mfma_f32_16x16x32_bf16 v[140:143], a[136:139], a[168:171], 0
    ds_read_b64_tr_b16 a[56:57], v229 offset:36864
    s_add_u32 m0, s81, 114688
    v_mfma_f32_16x16x32_bf16 v[140:143], a[140:143], a[172:175], v[140:143]
    buffer_load_dwordx4 v242, s[24:27], s59 offen offset:0 lds
    v_mfma_f32_16x16x32_bf16 v[144:147], a[128:131], a[176:179], 0
    ds_read_b64_tr_b16 a[58:59], v229 offset:38144
    v_or3_b32 v252, v252, v220, v222
    v_mfma_f32_16x16x32_bf16 v[144:147], a[132:135], a[180:183], v[144:147]
    ds_read_b64_tr_b16 a[60:61], v229 offset:47104
    v_and_b32 v252, 0xc000c000, v252
    v_mfma_f32_16x16x32_bf16 v[148:151], a[136:139], a[176:179], 0
    ds_read_b64_tr_b16 a[62:63], v229 offset:48384
    s_add_u32 m0, s79, 0
    v_mfma_f32_16x16x32_bf16 v[148:151], a[140:143], a[180:183], v[148:151]
    buffer_load_dwordx4 v234, s[16:19], s46 offen offset:0 lds
    v_mfma_f32_16x16x32_bf16 v[152:155], a[128:131], a[184:187], 0
    ds_read_b64_tr_b16 a[64:65], v247 offset:36864
    v_cmp_ne_u32 vcc, 0, v252
    v_mfma_f32_16x16x32_bf16 v[152:155], a[132:135], a[188:191], v[152:155]
    ds_read_b64_tr_b16 a[66:67], v247 offset:38144
    s_cbranch_vccnz L_pslow3
L_pback3:
    v_mfma_f32_16x16x32_bf16 v[156:159], a[136:139], a[184:187], 0
    ds_read_b64_tr_b16 a[68:69], v247 offset:47104
    v_mfma_f32_16x16x32_bf16 v[156:159], a[140:143], a[188:191], v[156:159]
    buffer_load_dwordx4 v235, s[16:19], s46 offen offset:1024 lds
    v_mfma_f32_16x16x32_bf16 v[160:163], a[128:131], a[0:3], 0
    ds_read_b64_tr_b16 a[70:71], v247 offset:48384
    v_mfma_f32_16x16x32_bf16 v[160:163], a[132:135], a[4:7], v[160:163]
    ds_read_b64_tr_b16 a[72:73], v248 offset:36896
    v_mfma_f32_16x16x32_bf16 v[164:167], a[136:139], a[0:3], 0
    ds_read_b64_tr_b16 a[74:75], v248 offset:38176
    v_mfma_f32_16x16x32_bf16 v[164:167], a[140:143], a[4:7], v[164:167]
    buffer_load_dwordx4 v236, s[16:19], s46 offen offset:2048 lds
    v_mfma_f32_16x16x32_bf16 v[64:67], v[100:103], v[220:223], v[64:67]
    ds_read_b64_tr_b16 a[76:77], v248 offset:47136
    v_mfma_f32_16x16x32_bf16 v[72:75], v[104:107], v[220:223], v[72:75]
    ds_read_b64_tr_b16 a[78:79], v248 offset:48416
    v_mfma_f32_16x16x32_bf16 v[76:79], v[108:111], v[220:223], v[76:79]
    v_mfma_f32_16x16x32_bf16 v[48:51], v[112:115], v[220:223], v[48:51]
    buffer_load_dwordx4 v237, s[16:19], s46 offen offset:3072 lds
    v_mfma_f32_16x16x32_bf16 v[56:59], v[116:119], v[220:223], v[56:59]
    v_mfma_f32_16x16x32_bf16 v[60:63], v[100:103], v[216:219], v[60:63]
    v_mfma_f32_16x16x32_bf16 v[68:71], v[104:107], v[216:219], v[68:71]
    s_add_u32 m0, s81, 0
    v_mfma_f32_16x16x32_bf16 v[40:43], v[108:111], v[216:219], v[40:43]
    buffer_load_dwordx4 v238, s[24:27], s60 offen offset:0 lds
    v_mfma_f32_16x16x32_bf16 v[44:47], v[112:115], v[216:219], v[44:47]
    v_mfma_f32_16x16x32_bf16 v[52:55], v[116:119], v[216:219], v[52:55]
    s_waitcnt vmcnt(16) lgkmcnt(0)
    s_barrier
    v_mfma_f32_16x16x32_bf16 v[24:27], v[80:83], v[212:215], v[24:27]
    ds_read_b128 a[128:131], v245 offset:0
    v_mfma_f32_16x16x32_bf16 v[32:35], v[84:87], v[212:215], v[32:35]
    ds_read_b128 a[132:135], v246 offset:0
    v_mfma_f32_16x16x32_bf16 v[36:39], v[88:91], v[212:215], v[36:39]
    ds_read_b128 a[136:139], v245 offset:2048
    v_mfma_f32_16x16x32_bf16 v[8:11], v[92:95], v[212:215], v[8:11]
    buffer_load_dwordx4 v239, s[24:27], s60 offen offset:1024 lds
    v_mfma_f32_16x16x32_bf16 v[16:19], v[96:99], v[212:215], v[16:19]
    ds_read_b128 a[140:143], v246 offset:2048
    v_mfma_f32_16x16x32_bf16 v[20:23], v[80:83], v[208:211], v[20:23]
    ds_read_b128 a[144:147], v245 offset:4096
    v_mfma_f32_16x16x32_bf16 v[28:31], v[84:87], v[208:211], v[28:31]
    ds_read_b128 a[148:151], v246 offset:4096
    v_mfma_f32_16x16x32_bf16 v[0:3], v[88:91], v[208:211], v[0:3]
    buffer_load_dwordx4 v240, s[24:27], s60 offen offset:2048 lds
    v_mfma_f32_16x16x32_bf16 v[4:7], v[92:95], v[208:211], v[4:7]
    ds_read_b128 a[152:155], v245 offset:6144
    v_mfma_f32_16x16x32_bf16 v[12:15], v[96:99], v[208:211], v[12:15]
    ds_read_b128 a[156:159], v246 offset:6144
    v_mfma_f32_16x16x32_bf16 v[168:171], a[24:27], a[40:43], v[168:171]
    ds_read_b64_tr_b16 a[160:161], v249 offset:128
    v_mfma_f32_16x16x32_bf16 v[168:171], a[28:31], a[44:47], v[168:171]
    ds_read_b64_tr_b16 a[162:163], v249 offset:1408
    v_mfma_f32_16x16x32_bf16 v[172:175], a[32:35], a[40:43], v[172:175]
    buffer_load_dwordx4 v241, s[24:27], s60 offen offset:3072 lds
    v_mfma_f32_16x16x32_bf16 v[172:175], a[36:39], a[44:47], v[172:175]
    ds_read_b64_tr_b16 a[164:165], v249 offset:10368
    v_mfma_f32_16x16x32_bf16 v[176:179], a[24:27], a[48:51], v[176:179]
    ds_read_b64_tr_b16 a[166:167], v249 offset:11648
    v_mfma_f32_16x16x32_bf16 v[176:179], a[28:31], a[52:55], v[176:179]
    ds_read_b64_tr_b16 a[168:169], v250 offset:160
    s_add_u32 m0, s81, 4096
    v_mfma_f32_16x16x32_bf16 v[180:183], a[32:35], a[48:51], v[180:183]
    buffer_load_dwordx4 v242, s[24:27], s60 offen offset:0 lds
    v_mfma_f32_16x16x32_bf16 v[180:183], a[36:39], a[52:55], v[180:183]
    ds_read_b64_tr_b16 a[170:171], v250 offset:1440
    v_cvt_pk_bf16_f32 v100, v168, v169
    v_mfma_f32_16x16x32_bf16 v[184:187], a[24:27], a[56:59], v[184:187]
    ds_read_b64_tr_b16 a[172:173], v250 offset:10400
    v_cvt_pk_bf16_f32 v101, v170, v171
    v_mfma_f32_16x16x32_bf16 v[184:187], a[28:31], a[60:63], v[184:187]
    ds_read_b64_tr_b16 a[174:175], v250 offset:11680
    v_cvt_pk_bf16_f32 v102, v172, v173
    v_mfma_f32_16x16x32_bf16 v[188:191], a[32:35], a[56:59], v[188:191]
    ds_read_b64_tr_b16 a[176:177], v253 offset:0
    s_add_u32 m0, s79, 36736
    v_mfma_f32_16x16x32_bf16 v[188:191], a[36:39], a[60:63], v[188:191]
    buffer_load_dwordx4 v234, s[16:19], s46 offen offset:128 lds
    v_mfma_f32_16x16x32_bf16 v[192:195], a[24:27], a[64:67], v[192:195]
    ds_read_b64_tr_b16 a[178:179], v253 offset:1280
    v_cvt_pk_bf16_f32 v103, v174, v175
    v_mfma_f32_16x16x32_bf16 v[192:195], a[28:31], a[68:71], v[192:195]
    ds_read_b64_tr_b16 a[180:181], v253 offset:10240
    v_cvt_pk_bf16_f32 v104, v176, v177
    v_mfma_f32_16x16x32_bf16 v[196:199], a[32:35], a[64:67], v[196:199]
    ds_read_b64_tr_b16 a[182:183], v253 offset:11520
    v_cvt_pk_bf16_f32 v105, v178, v179
    v_mfma_f32_16x16x32_bf16 v[196:199], a[36:39], a[68:71], v[196:199]
    buffer_load_dwordx4 v235, s[16:19], s46 offen offset:1152 lds
    v_mfma_f32_16x16x32_bf16 v[200:203], a[24:27], a[72:75], v[200:203]
    ds_read_b64_tr_b16 a[184:185], v249 offset:0
    v_cvt_pk_bf16_f32 v106, v180, v181
    v_mfma_f32_16x16x32_bf16 v[200:203], a[28:31], a[76:79], v[200:203]
    ds_read_b64_tr_b16 a[186:187], v249 offset:1280
    v_cvt_pk_bf16_f32 v107, v182, v183
    v_mfma_f32_16x16x32_bf16 v[204:207], a[32:35], a[72:75], v[204:207]
    ds_read_b64_tr_b16 a[188:189], v249 offset:10240
    v_cvt_pk_bf16_f32 v108, v184, v185
    v_mfma_f32_16x16x32_bf16 v[204:207], a[36:39], a[76:79], v[204:207]
    buffer_load_dwordx4 v236, s[16:19], s46 offen offset:2176 lds
    v_mfma_f32_16x16x32_bf16 v[128:131], a[8:11], a[40:43], v[128:131]
    ds_read_b64_tr_b16 a[190:191], v249 offset:11520
    v_cvt_pk_bf16_f32 v109, v186, v187
    v_mfma_f32_16x16x32_bf16 v[128:131], a[12:15], a[44:47], v[128:131]
    ds_read_b64_tr_b16 a[0:1], v250 offset:32
    v_cvt_pk_bf16_f32 v110, v188, v189
    v_mfma_f32_16x16x32_bf16 v[132:135], a[16:19], a[40:43], v[132:135]
    ds_read_b64_tr_b16 a[2:3], v250 offset:1312
    v_cvt_pk_bf16_f32 v111, v190, v191
    v_mfma_f32_16x16x32_bf16 v[132:135], a[20:23], a[44:47], v[132:135]
    ds_read_b64_tr_b16 a[4:5], v250 offset:10272
    v_cvt_pk_bf16_f32 v112, v192, v193
    v_mfma_f32_16x16x32_bf16 v[136:139], a[8:11], a[48:51], v[136:139]
    buffer_load_dwordx4 v237, s[16:19], s46 offen offset:3200 lds
    v_mfma_f32_16x16x32_bf16 v[136:139], a[12:15], a[52:55], v[136:139]
    ds_read_b64_tr_b16 a[6:7], v250 offset:11552
    v_cvt_pk_bf16_f32 v113, v194, v195
    v_mfma_f32_16x16x32_bf16 v[140:143], a[16:19], a[48:51], v[140:143]
    v_cvt_pk_bf16_f32 v114, v196, v197
    v_cvt_pk_bf16_f32 v115, v198, v199
    v_mfma_f32_16x16x32_bf16 v[140:143], a[20:23], a[52:55], v[140:143]
    s_add_u32 m0, s81, 36864
    v_cvt_pk_bf16_f32 v116, v200, v201
    v_mfma_f32_16x16x32_bf16 v[144:147], a[8:11], a[56:59], v[144:147]
    buffer_load_dwordx4 v238, s[24:27], s61 offen offset:0 lds
    v_mfma_f32_16x16x32_bf16 v[144:147], a[12:15], a[60:63], v[144:147]
    v_cvt_pk_bf16_f32 v117, v202, v203
    v_cvt_pk_bf16_f32 v118, v204, v205
    v_mfma_f32_16x16x32_bf16 v[148:151], a[16:19], a[56:59], v[148:151]
    v_cvt_pk_bf16_f32 v119, v206, v207
    v_cvt_pk_bf16_f32 v80, v128, v129
    v_mfma_f32_16x16x32_bf16 v[148:151], a[20:23], a[60:63], v[148:151]
    v_cvt_pk_bf16_f32 v81, v130, v131
    v_cvt_pk_bf16_f32 v82, v132, v133
    v_mfma_f32_16x16x32_bf16 v[152:155], a[8:11], a[64:67], v[152:155]
    v_cvt_pk_bf16_f32 v83, v134, v135
    v_cvt_pk_bf16_f32 v84, v136, v137
    v_mfma_f32_16x16x32_bf16 v[152:155], a[12:15], a[68:71], v[152:155]
    buffer_load_dwordx4 v239, s[24:27], s61 offen offset:1024 lds
    v_mfma_f32_16x16x32_bf16 v[156:159], a[16:19], a[64:67], v[156:159]
    v_cvt_pk_bf16_f32 v85, v138, v139
    v_cvt_pk_bf16_f32 v86, v140, v141
    v_mfma_f32_16x16x32_bf16 v[156:159], a[20:23], a[68:71], v[156:159]
    v_cvt_pk_bf16_f32 v87, v142, v143
    v_cvt_pk_bf16_f32 v88, v144, v145
    v_mfma_f32_16x16x32_bf16 v[160:163], a[8:11], a[72:75], v[160:163]
    v_cvt_pk_bf16_f32 v89, v146, v147
    v_cvt_pk_bf16_f32 v90, v148, v149
    v_mfma_f32_16x16x32_bf16 v[160:163], a[12:15], a[76:79], v[160:163]
    buffer_load_dwordx4 v240, s[24:27], s61 offen offset:2048 lds
    v_mfma_f32_16x16x32_bf16 v[164:167], a[16:19], a[72:75], v[164:167]
    v_cvt_pk_bf16_f32 v91, v150, v151
    v_cvt_pk_bf16_f32 v92, v152, v153
    v_mfma_f32_16x16x32_bf16 v[164:167], a[20:23], a[76:79], v[164:167]
    v_cvt_pk_bf16_f32 v93, v154, v155
    v_cvt_pk_bf16_f32 v94, v156, v157
    s_waitcnt vmcnt(16) lgkmcnt(0)
    s_barrier
    v_mfma_f32_16x16x32_bf16 v[168:171], a[144:147], a[160:163], 0
    ds_read_b128 v[208:211], v251 offset:0
    s_add_u32 s90, s92, s45
    v_mfma_f32_16x16x32_bf16 v[168:171], a[148:151], a[164:167], v[168:171]
    ds_read_b128 v[212:215], v251 offset:1024
    s_add_u32 m0, s83, 8192
    v_mfma_f32_16x16x32_bf16 v[172:175], a[152:155], a[160:163], 0
    buffer_load_dwordx4 v232, s[36:39], s90 offen offset:0 sc1 lds
    v_mfma_f32_16x16x32_bf16 v[172:175], a[156:159], a[164:167], v[172:175]
    ds_read_b128 v[216:219], v251 offset:2048
    v_cvt_pk_bf16_f32 v95, v158, v159
    v_mfma_f32_16x16x32_bf16 v[176:179], a[144:147], a[168:171], 0
    ds_read_b128 v[220:223], v251 offset:3072
    v_cvt_pk_bf16_f32 v96, v160, v161
    v_mfma_f32_16x16x32_bf16 v[176:179], a[148:151], a[172:175], v[176:179]
    ds_read_b128 a[8:11], v245 offset:36864
    v_cvt_pk_bf16_f32 v97, v162, v163
    v_mfma_f32_16x16x32_bf16 v[180:183], a[152:155], a[168:171], 0
    buffer_load_dwordx4 v232, s[36:39], s90 offen offset:1024 sc1 lds
    v_mfma_f32_16x16x32_bf16 v[180:183], a[156:159], a[172:175], v[180:183]
    ds_read_b128 a[12:15], v246 offset:36864
    v_cvt_pk_bf16_f32 v98, v164, v165
    v_mfma_f32_16x16x32_bf16 v[184:187], a[144:147], a[176:179], 0
    ds_read_b128 a[16:19], v245 offset:38912
    v_cvt_pk_bf16_f32 v99, v166, v167
    v_mfma_f32_16x16x32_bf16 v[184:187], a[148:151], a[180:183], v[184:187]
    ds_read_b128 a[20:23], v246 offset:38912
    s_add_u32 m0, s81, 36864
    v_mfma_f32_16x16x32_bf16 v[188:191], a[152:155], a[176:179], 0
    buffer_load_dwordx4 v241, s[24:27], s61 offen offset:3072 lds
    v_mfma_f32_16x16x32_bf16 v[188:191], a[156:159], a[180:183], v[188:191]
    ds_read_b128 a[24:27], v245 offset:40960
    s_waitcnt lgkmcnt(5)
    v_mfma_f32_16x16x32_bf16 v[192:195], a[144:147], a[184:187], 0
    ds_read_b128 a[28:31], v246 offset:40960
    v_xor_b32 v208, v224, v208
    v_mfma_f32_16x16x32_bf16 v[192:195], a[148:151], a[188:191], v[192:195]
    ds_read_b128 a[32:35], v245 offset:43008
    s_add_u32 m0, s81, 40960
    v_mfma_f32_16x16x32_bf16 v[196:199], a[152:155], a[184:187], 0
    buffer_load_dwordx4 v242, s[24:27], s61 offen offset:0 lds
    v_mfma_f32_16x16x32_bf16 v[196:199], a[156:159], a[188:191], v[196:199]
    ds_read_b128 a[36:39], v246 offset:43008
    v_xor_b32 v210, v225, v210
    v_mfma_f32_16x16x32_bf16 v[200:203], a[144:147], a[0:3], 0
    ds_read_b64_tr_b16 a[40:41], v249 offset:36992
    s_add_u32 m0, s79, 73728
    v_mfma_f32_16x16x32_bf16 v[200:203], a[148:151], a[4:7], v[200:203]
    buffer_load_dwordx4 v234, s[16:19], s47 offen offset:0 lds
    v_mfma_f32_16x16x32_bf16 v[204:207], a[152:155], a[0:3], 0
    ds_read_b64_tr_b16 a[42:43], v249 offset:38272
    v_or_b32 v252, v208, v210
    v_mfma_f32_16x16x32_bf16 v[204:207], a[156:159], a[4:7], v[204:207]
    ds_read_b64_tr_b16 a[44:45], v249 offset:47232
    v_xor_b32 v212, v224, v212
    v_mfma_f32_16x16x32_bf16 v[128:131], a[128:131], a[160:163], 0
    ds_read_b64_tr_b16 a[46:47], v249 offset:48512
    v_xor_b32 v214, v225, v214
    v_mfma_f32_16x16x32_bf16 v[128:131], a[132:135], a[164:167], v[128:131]
    buffer_load_dwordx4 v235, s[16:19], s47 offen offset:1024 lds
    v_mfma_f32_16x16x32_bf16 v[132:135], a[136:139], a[160:163], 0
    ds_read_b64_tr_b16 a[48:49], v250 offset:37024
    v_or3_b32 v252, v252, v212, v214
    v_mfma_f32_16x16x32_bf16 v[132:135], a[140:143], a[164:167], v[132:135]
    ds_read_b64_tr_b16 a[50:51], v250 offset:38304
    v_xor_b32 v216, v224, v216
    v_mfma_f32_16x16x32_bf16 v[136:139], a[128:131], a[168:171], 0
    ds_read_b64_tr_b16 a[52:53], v250 offset:47264
    v_xor_b32 v218, v225, v218
    v_mfma_f32_16x16x32_bf16 v[136:139], a[132:135], a[172:175], v[136:139]
    buffer_load_dwordx4 v236, s[16:19], s47 offen offset:2048 lds
    v_mfma_f32_16x16x32_bf16 v[140:143], a[136:139], a[168:171], 0
    ds_read_b64_tr_b16 a[54:55], v250 offset:48544
    v_or3_b32 v252, v252, v216, v218
    v_mfma_f32_16x16x32_bf16 v[140:143], a[140:143], a[172:175], v[140:143]
    ds_read_b64_tr_b16 a[56:57], v253 offset:36864
    v_xor_b32 v220, v224, v220
    v_mfma_f32_16x16x32_bf16 v[144:147], a[128:131], a[176:179], 0
    ds_read_b64_tr_b16 a[58:59], v253 offset:38144
    v_xor_b32 v222, v225, v222
    v_mfma_f32_16x16x32_bf16 v[144:147], a[132:135], a[180:183], v[144:147]
    buffer_load_dwordx4 v237, s[16:19], s47 offen offset:3072 lds
    v_mfma_f32_16x16x32_bf16 v[148:151], a[136:139], a[176:179], 0
    ds_read_b64_tr_b16 a[60:61], v253 offset:47104
    v_or3_b32 v252, v252, v220, v222
    v_mfma_f32_16x16x32_bf16 v[148:151], a[140:143], a[180:183], v[148:151]
    ds_read_b64_tr_b16 a[62:63], v253 offset:48384
    v_and_b32 v252, 0xc000c000, v252
    v_mfma_f32_16x16x32_bf16 v[152:155], a[128:131], a[184:187], 0
    ds_read_b64_tr_b16 a[64:65], v249 offset:36864
    s_add_u32 m0, s81, 73728
    v_mfma_f32_16x16x32_bf16 v[152:155], a[132:135], a[188:191], v[152:155]
    buffer_load_dwordx4 v238, s[24:27], s62 offen offset:0 lds
    v_mfma_f32_16x16x32_bf16 v[156:159], a[136:139], a[184:187], 0
    ds_read_b64_tr_b16 a[66:67], v249 offset:38144
    v_cmp_ne_u32 vcc, 0, v252
    v_mfma_f32_16x16x32_bf16 v[156:159], a[140:143], a[188:191], v[156:159]
    ds_read_b64_tr_b16 a[68:69], v249 offset:47104
    s_cbranch_vccnz L_pslow4
L_pback4:
    v_mfma_f32_16x16x32_bf16 v[160:163], a[128:131], a[0:3], 0
    buffer_load_dwordx4 v239, s[24:27], s62 offen offset:1024 lds
    v_mfma_f32_16x16x32_bf16 v[160:163], a[132:135], a[4:7], v[160:163]
    ds_read_b64_tr_b16 a[70:71], v249 offset:48384
    v_mfma_f32_16x16x32_bf16 v[164:167], a[136:139], a[0:3], 0
    ds_read_b64_tr_b16 a[72:73], v250 offset:36896
    v_mfma_f32_16x16x32_bf16 v[164:167], a[140:143], a[4:7], v[164:167]
    ds_read_b64_tr_b16 a[74:75], v250 offset:38176
    v_mfma_f32_16x16x32_bf16 v[64:67], v[100:103], v[220:223], v[64:67]
    buffer_load_dwordx4 v240, s[24:27], s62 offen offset:2048 lds
    v_mfma_f32_16x16x32_bf16 v[72:75], v[104:107], v[220:223], v[72:75]
    ds_read_b64_tr_b16 a[76:77], v250 offset:47136
    v_mfma_f32_16x16x32_bf16 v[76:79], v[108:111], v[220:223], v[76:79]
    ds_read_b64_tr_b16 a[78:79], v250 offset:48416
    v_mfma_f32_16x16x32_bf16 v[48:51], v[112:115], v[220:223], v[48:51]
    v_mfma_f32_16x16x32_bf16 v[56:59], v[116:119], v[220:223], v[56:59]
    buffer_load_dwordx4 v241, s[24:27], s62 offen offset:3072 lds
    v_mfma_f32_16x16x32_bf16 v[60:63], v[100:103], v[216:219], v[60:63]
    v_mfma_f32_16x16x32_bf16 v[68:71], v[104:107], v[216:219], v[68:71]
    v_mfma_f32_16x16x32_bf16 v[40:43], v[108:111], v[216:219], v[40:43]
    s_add_u32 m0, s81, 77824
    v_mfma_f32_16x16x32_bf16 v[44:47], v[112:115], v[216:219], v[44:47]
    buffer_load_dwordx4 v242, s[24:27], s62 offen offset:0 lds
    v_mfma_f32_16x16x32_bf16 v[52:55], v[116:119], v[216:219], v[52:55]
    s_waitcnt vmcnt(20) lgkmcnt(0)
    s_barrier
    v_mfma_f32_16x16x32_bf16 v[24:27], v[80:83], v[212:215], v[24:27]
    ds_read_b128 a[128:131], v243 offset:0
    s_add_u32 s90, s92, s46
    v_mfma_f32_16x16x32_bf16 v[32:35], v[84:87], v[212:215], v[32:35]
    ds_read_b128 a[132:135], v244 offset:0
    s_add_u32 m0, s83, 0
    v_mfma_f32_16x16x32_bf16 v[36:39], v[88:91], v[212:215], v[36:39]
    buffer_load_dwordx4 v232, s[36:39], s90 offen offset:0 sc1 lds
    v_mfma_f32_16x16x32_bf16 v[8:11], v[92:95], v[212:215], v[8:11]
    ds_read_b128 a[136:139], v243 offset:2048
    v_mfma_f32_16x16x32_bf16 v[16:19], v[96:99], v[212:215], v[16:19]
    ds_read_b128 a[140:143], v244 offset:2048
    v_mfma_f32_16x16x32_bf16 v[20:23], v[80:83], v[208:211], v[20:23]
    buffer_load_dwordx4 v232, s[36:39], s90 offen offset:1024 sc1 lds
    v_mfma_f32_16x16x32_bf16 v[28:31], v[84:87], v[208:211], v[28:31]
    ds_read_b128 a[144:147], v243 offset:4096
    v_mfma_f32_16x16x32_bf16 v[0:3], v[88:91], v[208:211], v[0:3]
    ds_read_b128 a[148:151], v244 offset:4096
    s_add_u32 m0, s79, 110464
    v_mfma_f32_16x16x32_bf16 v[4:7], v[92:95], v[208:211], v[4:7]
    buffer_load_dwordx4 v234, s[16:19], s47 offen offset:128 lds
    v_mfma_f32_16x16x32_bf16 v[12:15], v[96:99], v[208:211], v[12:15]
    ds_read_b128 a[152:155], v243 offset:6144
    v_mfma_f32_16x16x32_bf16 v[168:171], a[24:27], a[40:43], v[168:171]
    ds_read_b128 a[156:159], v244 offset:6144
    v_mfma_f32_16x16x32_bf16 v[168:171], a[28:31], a[44:47], v[168:171]
    ds_read_b64_tr_b16 a[160:161], v247 offset:128
    v_mfma_f32_16x16x32_bf16 v[172:175], a[32:35], a[40:43], v[172:175]
    buffer_load_dwordx4 v235, s[16:19], s47 offen offset:1152 lds
    v_mfma_f32_16x16x32_bf16 v[172:175], a[36:39], a[44:47], v[172:175]
    ds_read_b64_tr_b16 a[162:163], v247 offset:1408
    v_mfma_f32_16x16x32_bf16 v[176:179], a[24:27], a[48:51], v[176:179]
    ds_read_b64_tr_b16 a[164:165], v247 offset:10368
    v_mfma_f32_16x16x32_bf16 v[176:179], a[28:31], a[52:55], v[176:179]
    buffer_load_dwordx4 v236, s[16:19], s47 offen offset:2176 lds
    v_mfma_f32_16x16x32_bf16 v[180:183], a[32:35], a[48:51], v[180:183]
    ds_read_b64_tr_b16 a[166:167], v247 offset:11648
    v_cvt_pk_bf16_f32 v100, v168, v169
L_pad6:
    s_cbranch_execz L_hop2
    v_mfma_f32_16x16x32_bf16 v[180:183], a[36:39], a[52:55], v[180:183]
    ds_read_b64_tr_b16 a[168:169], v248 offset:160
    v_cvt_pk_bf16_f32 v101, v170, v171
    v_mfma_f32_16x16x32_bf16 v[184:187], a[24:27], a[56:59], v[184:187]
    buffer_load_dwordx4 v237, s[16:19], s47 offen offset:3200 lds
    v_mfma_f32_16x16x32_bf16 v[184:187], a[28:31], a[60:63], v[184:187]
    ds_read_b64_tr_b16 a[170:171], v248 offset:1440
    v_cvt_pk_bf16_f32 v102, v172, v173
    v_mfma_f32_16x16x32_bf16 v[188:191], a[32:35], a[56:59], v[188:191]
    ds_read_b64_tr_b16 a[172:173], v248 offset:10400
    s_add_u32 m0, s81, 110592
    v_mfma_f32_16x16x32_bf16 v[188:191], a[36:39], a[60:63], v[188:191]
    buffer_load_dwordx4 v238, s[24:27], s63 offen offset:0 lds
    v_mfma_f32_16x16x32_bf16 v[192:195], a[24:27], a[64:67], v[192:195]
    ds_read_b64_tr_b16 a[174:175], v248 offset:11680
    v_cvt_pk_bf16_f32 v103, v174, v175
    v_mfma_f32_16x16x32_bf16 v[192:195], a[28:31], a[68:71], v[192:195]
    ds_read_b64_tr_b16 a[176:177], v229 offset:0
    v_cvt_pk_bf16_f32 v104, v176, v177
    v_mfma_f32_16x16x32_bf16 v[196:199], a[32:35], a[64:67], v[196:199]
    buffer_load_dwordx4 v239, s[24:27], s63 offen offset:1024 lds
    v_mfma_f32_16x16x32_bf16 v[196:199], a[36:39], a[68:71], v[196:199]
    ds_read_b64_tr_b16 a[178:179], v229 offset:1280
    v_cvt_pk_bf16_f32 v105, v178, v179
    v_mfma_f32_16x16x32_bf16 v[200:203], a[24:27], a[72:75], v[200:203]
    ds_read_b64_tr_b16 a[180:181], v229 offset:10240
    v_cvt_pk_bf16_f32 v106, v180, v181
    v_mfma_f32_16x16x32_bf16 v[200:203], a[28:31], a[76:79], v[200:203]
    ds_read_b64_tr_b16 a[182:183], v229 offset:11520
    v_cvt_pk_bf16_f32 v107, v182, v183
    v_mfma_f32_16x16x32_bf16 v[204:207], a[32:35], a[72:75], v[204:207]
    buffer_load_dwordx4 v240, s[24:27], s63 offen offset:2048 lds
    v_mfma_f32_16x16x32_bf16 v[204:207], a[36:39], a[76:79], v[204:207]
    ds_read_b64_tr_b16 a[184:185], v247 offset:0
    v_cvt_pk_bf16_f32 v108, v184, v185
    v_mfma_f32_16x16x32_bf16 v[128:131], a[8:11], a[40:43], v[128:131]
    ds_read_b64_tr_b16 a[186:187], v247 offset:1280
    v_cvt_pk_bf16_f32 v109, v186, v187
    v_mfma_f32_16x16x32_bf16 v[128:131], a[12:15], a[44:47], v[128:131]
    buffer_load_dwordx4 v241, s[24:27], s63 offen offset:3072 lds
    v_mfma_f32_16x16x32_bf16 v[132:135], a[16:19], a[40:43], v[132:135]
    ds_read_b64_tr_b16 a[188:189], v247 offset:10240
    v_cvt_pk_bf16_f32 v110, v188, v189
    v_mfma_f32_16x16x32_bf16 v[132:135], a[20:23], a[44:47], v[132:135]
    ds_read_b64_tr_b16 a[190:191], v247 offset:11520
    s_add_u32 m0, s81, 114688
    v_mfma_f32_16x16x32_bf16 v[136:139], a[8:11], a[48:51], v[136:139]
    buffer_load_dwordx4 v242, s[24:27], s63 offen offset:0 lds
    v_mfma_f32_16x16x32_bf16 v[136:139], a[12:15], a[52:55], v[136:139]
    ds_read_b64_tr_b16 a[0:1], v248 offset:32
    v_cvt_pk_bf16_f32 v111, v190, v191
    v_mfma_f32_16x16x32_bf16 v[140:143], a[16:19], a[48:51], v[140:143]
    ds_read_b64_tr_b16 a[2:3], v248 offset:1312
    v_cvt_pk_bf16_f32 v112, v192, v193
    v_mfma_f32_16x16x32_bf16 v[140:143], a[20:23], a[52:55], v[140:143]
    ds_read_b64_tr_b16 a[4:5], v248 offset:10272
    v_cvt_pk_bf16_f32 v113, v194, v195
    v_mfma_f32_16x16x32_bf16 v[144:147], a[8:11], a[56:59], v[144:147]
    ds_read_b64_tr_b16 a[6:7], v248 offset:11552
    v_cvt_pk_bf16_f32 v114, v196, v197
    v_mfma_f32_16x16x32_bf16 v[144:147], a[12:15], a[60:63], v[144:147]
    v_cvt_pk_bf16_f32 v115, v198, v199
    v_cvt_pk_bf16_f32 v116, v200, v201
    v_mfma_f32_16x16x32_bf16 v[148:151], a[16:19], a[56:59], v[148:151]
    v_cvt_pk_bf16_f32 v117, v202, v203
    v_cvt_pk_bf16_f32 v118, v204, v205
    v_mfma_f32_16x16x32_bf16 v[148:151], a[20:23], a[60:63], v[148:151]
    v_cvt_pk_bf16_f32 v119, v206, v207
    v_cvt_pk_bf16_f32 v80, v128, v129
    v_mfma_f32_16x16x32_bf16 v[152:155], a[8:11], a[64:67], v[152:155]
    v_cvt_pk_bf16_f32 v81, v130, v131
    v_cvt_pk_bf16_f32 v82, v132, v133
    v_mfma_f32_16x16x32_bf16 v[152:155], a[12:15], a[68:71], v[152:155]
    v_cvt_pk_bf16_f32 v83, v134, v135
    v_cvt_pk_bf16_f32 v84, v136, v137
    v_mfma_f32_16x16x32_bf16 v[156:159], a[16:19], a[64:67], v[156:159]
    v_cvt_pk_bf16_f32 v85, v138, v139
    v_cvt_pk_bf16_f32 v86, v140, v141
    v_mfma_f32_16x16x32_bf16 v[156:159], a[20:23], a[68:71], v[156:159]
    v_cvt_pk_bf16_f32 v87, v142, v143
    v_cvt_pk_bf16_f32 v88, v144, v145
    v_mfma_f32_16x16x32_bf16 v[160:163], a[8:11], a[72:75], v[160:163]
    v_cvt_pk_bf16_f32 v89, v146, v147
    v_cvt_pk_bf16_f32 v90, v148, v149
    v_mfma_f32_16x16x32_bf16 v[160:163], a[12:15], a[76:79], v[160:163]
    v_cvt_pk_bf16_f32 v91, v150, v151
    v_cvt_pk_bf16_f32 v92, v152, v153
    v_mfma_f32_16x16x32_bf16 v[164:167], a[16:19], a[72:75], v[164:167]
    v_cvt_pk_bf16_f32 v93, v154, v155
    v_mfma_f32_16x16x32_bf16 v[164:167], a[20:23], a[76:79], v[164:167]
    v_cvt_pk_bf16_f32 v94, v156, v157
    v_cvt_pk_bf16_f32 v95, v158, v159
    s_waitcnt vmcnt(9) lgkmcnt(0)
    s_barrier
    v_mfma_f32_16x16x32_bf16 v[168:171], a[144:147], a[160:163], 0
    ds_read_b128 v[216:219], v251 offset:10240
    v_cvt_pk_bf16_f32 v96, v160, v161
    v_mfma_f32_16x16x32_bf16 v[168:171], a[148:151], a[164:167], v[168:171]
    ds_read_b128 v[220:223], v251 offset:11264
    v_cvt_pk_bf16_f32 v97, v162, v163
    v_mfma_f32_16x16x32_bf16 v[172:175], a[152:155], a[160:163], 0
    ds_read_b128 v[208:211], v251 offset:8192
    v_cvt_pk_bf16_f32 v98, v164, v165
    v_mfma_f32_16x16x32_bf16 v[172:175], a[156:159], a[164:167], v[172:175]
    ds_read_b128 v[212:215], v251 offset:9216
    v_cvt_pk_bf16_f32 v99, v166, v167
    v_mfma_f32_16x16x32_bf16 v[176:179], a[144:147], a[168:171], 0
    ds_read_b128 v[120:123], v251 offset:2048
    v_mfma_f32_16x16x32_bf16 v[176:179], a[148:151], a[172:175], v[176:179]
    ds_read_b128 v[124:127], v251 offset:3072
    s_waitcnt lgkmcnt(5)
    v_xor_b32 v216, v224, v216
    v_mfma_f32_16x16x32_bf16 v[180:183], a[152:155], a[168:171], 0
    ds_read_b128 a[24:27], v243 offset:40960
    v_xor_b32 v218, v225, v218
    v_mfma_f32_16x16x32_bf16 v[180:183], a[156:159], a[172:175], v[180:183]
    ds_read_b128 a[28:31], v244 offset:40960
    v_or_b32 v252, v216, v218
    v_mfma_f32_16x16x32_bf16 v[184:187], a[144:147], a[176:179], 0
    ds_read_b128 a[32:35], v243 offset:43008
    s_waitcnt lgkmcnt(6)
    v_xor_b32 v220, v224, v220
    v_mfma_f32_16x16x32_bf16 v[184:187], a[148:151], a[180:183], v[184:187]
    ds_read_b128 a[36:39], v244 offset:43008
    v_xor_b32 v222, v225, v222
    v_mfma_f32_16x16x32_bf16 v[188:191], a[152:155], a[176:179], 0
    ds_read_b64_tr_b16 a[40:41], v247 offset:36992
    v_or3_b32 v252, v252, v220, v222
    v_mfma_f32_16x16x32_bf16 v[188:191], a[156:159], a[180:183], v[188:191]
    ds_read_b64_tr_b16 a[42:43], v247 offset:38272
    v_and_b32 v252, 0xc000c000, v252
    s_waitcnt vmcnt(0) lgkmcnt(5)
    s_barrier
    v_mfma_f32_16x16x32_bf16 v[192:195], a[144:147], a[184:187], 0
    s_add_u32 s90, s92, s47
    s_add_u32 m0, s83, 8192
    s_nop 0
    buffer_load_dwordx4 v232, s[36:39], s90 offen offset:0 sc1 lds
    v_cmp_ne_u32 vcc, 0, v252
    v_mfma_f32_16x16x32_bf16 v[192:195], a[148:151], a[188:191], v[192:195]
    buffer_load_dwordx4 v232, s[36:39], s90 offen offset:1024 sc1 lds
    s_cbranch_vccnz L_pslow5_1
L_pback5_1:
    v_mfma_f32_16x16x32_bf16 v[196:199], a[152:155], a[184:187], 0
    ds_read_b64_tr_b16 a[44:45], v247 offset:47232
    v_mfma_f32_16x16x32_bf16 v[196:199], a[156:159], a[188:191], v[196:199]
    ds_read_b64_tr_b16 a[46:47], v247 offset:48512
    v_mfma_f32_16x16x32_bf16 v[200:203], a[144:147], a[0:3], 0
    ds_read_b128 a[224:227], v245 offset:4096
    v_mfma_f32_16x16x32_bf16 v[200:203], a[148:151], a[4:7], v[200:203]
    ds_read_b128 a[228:231], v246 offset:4096
    v_mfma_f32_16x16x32_bf16 v[204:207], a[152:155], a[0:3], 0
    ds_read_b64_tr_b16 a[80:81], v249 offset:128
    v_mfma_f32_16x16x32_bf16 v[204:207], a[156:159], a[4:7], v[204:207]
    ds_read_b64_tr_b16 a[82:83], v249 offset:1408
    v_mfma_f32_16x16x32_bf16 v[64:67], v[100:103], v[220:223], v[64:67]
    ds_read_b64_tr_b16 a[84:85], v249 offset:10368
    v_xor_b32 v120, v224, v120
    v_mfma_f32_16x16x32_bf16 v[60:63], v[100:103], v[216:219], v[60:63]
    ds_read_b64_tr_b16 a[86:87], v249 offset:11648
    v_xor_b32 v122, v225, v122
    v_mfma_f32_16x16x32_bf16 v[72:75], v[104:107], v[220:223], v[72:75]
    ds_read_b128 a[240:243], v245 offset:40960
    v_or_b32 v252, v120, v122
    v_mfma_f32_16x16x32_bf16 v[68:71], v[104:107], v[216:219], v[68:71]
    ds_read_b128 a[244:247], v246 offset:40960
    v_xor_b32 v124, v224, v124
    v_mfma_f32_16x16x32_bf16 v[76:79], v[108:111], v[220:223], v[76:79]
    ds_read_b64_tr_b16 a[120:121], v249 offset:36992
    v_xor_b32 v126, v225, v126
    v_mfma_f32_16x16x32_bf16 v[40:43], v[108:111], v[216:219], v[40:43]
    ds_read_b64_tr_b16 a[122:123], v249 offset:38272
    v_or3_b32 v252, v252, v124, v126
    v_mfma_f32_16x16x32_bf16 v[48:51], v[112:115], v[220:223], v[48:51]
    ds_read_b64_tr_b16 a[124:125], v249 offset:47232
    v_and_b32 v252, 0xc000c000, v252
    v_mfma_f32_16x16x32_bf16 v[44:47], v[112:115], v[216:219], v[44:47]
    ds_read_b64_tr_b16 a[126:127], v249 offset:48512
    v_cmp_ne_u32 vcc, 0, v252
    v_mfma_f32_16x16x32_bf16 v[56:59], v[116:119], v[220:223], v[56:59]
    ds_read_b128 a[232:235], v245 offset:6144
    s_cbranch_vccnz L_pslow6_1
L_pback6_1:
    v_mfma_f32_16x16x32_bf16 v[52:55], v[116:119], v[216:219], v[52:55]
    ds_read_b128 a[236:239], v246 offset:6144
    s_waitcnt lgkmcnt(6)
    v_mfma_f32_16x16x32_bf16 v[168:171], a[24:27], a[40:43], v[168:171]
    ds_read_b128 a[248:251], v245 offset:43008
    v_mfma_f32_16x16x32_bf16 v[168:171], a[28:31], a[44:47], v[168:171]
    ds_read_b128 a[252:255], v246 offset:43008
    v_mfma_f32_16x16x32_bf16 v[172:175], a[32:35], a[40:43], v[172:175]
    ds_read_b64_tr_b16 a[48:49], v248 offset:37024
    v_mfma_f32_16x16x32_bf16 v[172:175], a[36:39], a[44:47], v[172:175]
    ds_read_b64_tr_b16 a[50:51], v248 offset:38304
    v_mfma_f32_16x16x32_bf16 v[128:131], a[224:227], a[80:83], 0
    ds_read_b64_tr_b16 a[52:53], v248 offset:47264
    v_mfma_f32_16x16x32_bf16 v[128:131], a[228:231], a[84:87], v[128:131]
    ds_read_b64_tr_b16 a[54:55], v248 offset:48544
    v_cvt_pk_bf16_f32 v100, v168, v169
    s_waitcnt lgkmcnt(6)
    v_mfma_f32_16x16x32_bf16 v[128:131], a[240:243], a[120:123], v[128:131]
    ds_read_b64_tr_b16 a[88:89], v250 offset:160
    v_cvt_pk_bf16_f32 v101, v170, v171
    v_mfma_f32_16x16x32_bf16 v[128:131], a[244:247], a[124:127], v[128:131]
    ds_read_b64_tr_b16 a[90:91], v250 offset:1440
    s_add_u32 s4, s96, 12288
    v_mfma_f32_16x16x32_bf16 v[132:135], a[232:235], a[80:83], 0
    ds_read_b64_tr_b16 a[92:93], v250 offset:10400
    s_add_u32 s5, s96, 24576
    v_mfma_f32_16x16x32_bf16 v[132:135], a[236:239], a[84:87], v[132:135]
    ds_read_b64_tr_b16 a[94:95], v250 offset:11680
    s_mov_b32 s99, 0xffff0000
    s_mov_b32 s88, 0
    v_not_b32 v255, v230
    v_cvt_pk_bf16_f32 v102, v172, v173
    v_cvt_pk_bf16_f32 v103, v174, v175
    s_nop 1
    v_mfma_f32_16x16x32_bf16 v[64:67], v[100:103], v[124:127], v[64:67]
    ds_read_b64_tr_b16 a[192:193], v250 offset:37024
    v_mfma_f32_16x16x32_bf16 v[60:63], v[100:103], v[120:123], v[60:63]
    ds_read_b64_tr_b16 a[194:195], v250 offset:38304
    s_waitcnt lgkmcnt(6)
    v_mfma_f32_16x16x32_bf16 v[132:135], a[248:251], a[120:123], v[132:135]
    ds_read_b64_tr_b16 a[196:197], v250 offset:47264
    v_cvt_pk_bf16_f32 v100, v128, v129
    v_mfma_f32_16x16x32_bf16 v[132:135], a[252:255], a[124:127], v[132:135]
    ds_read_b64_tr_b16 a[198:199], v250 offset:48544
    v_cvt_pk_bf16_f32 v101, v130, v131
    v_mfma_f32_16x16x32_bf16 v[176:179], a[24:27], a[48:51], v[176:179]
    ds_read_b64_tr_b16 a[56:57], v229 offset:36864
    v_mfma_f32_16x16x32_bf16 v[176:179], a[28:31], a[52:55], v[176:179]
    ds_read_b64_tr_b16 a[58:59], v229 offset:38144
    v_mfma_f32_16x16x32_bf16 v[180:183], a[32:35], a[48:51], v[180:183]
    ds_read_b64_tr_b16 a[60:61], v229 offset:47104
    v_mfma_f32_16x16x32_bf16 v[180:183], a[36:39], a[52:55], v[180:183]
    ds_read_b64_tr_b16 a[62:63], v229 offset:48384
    v_cvt_pk_bf16_f32 v102, v132, v133
    s_waitcnt lgkmcnt(6)
    v_mfma_f32_16x16x32_bf16 v[136:139], a[224:227], a[88:91], 0
    ds_read_b64_tr_b16 a[96:97], v253 offset:0
    v_cvt_pk_bf16_f32 v103, v134, v135
    v_mfma_f32_16x16x32_bf16 v[136:139], a[228:231], a[92:95], v[136:139]
    ds_read_b64_tr_b16 a[98:99], v253 offset:1280
    v_cvt_pk_bf16_f32 v104, v176, v177
    v_mfma_f32_16x16x32_bf16 v[136:139], a[240:243], a[192:195], v[136:139]
    ds_read_b64_tr_b16 a[100:101], v253 offset:10240
    v_cvt_pk_bf16_f32 v105, v178, v179
    s_waitcnt lgkmcnt(6)
    v_mfma_f32_16x16x32_bf16 v[136:139], a[244:247], a[196:199], v[136:139]
    ds_read_b64_tr_b16 a[102:103], v253 offset:11520
    v_cvt_pk_bf16_f32 v106, v180, v181
    v_mfma_f32_16x16x32_bf16 v[140:143], a[232:235], a[88:91], 0
    ds_read_b64_tr_b16 a[200:201], v253 offset:36864
    v_cvt_pk_bf16_f32 v107, v182, v183
    v_mfma_f32_16x16x32_bf16 v[140:143], a[236:239], a[92:95], v[140:143]
    ds_read_b64_tr_b16 a[202:203], v253 offset:38144
    s_waitcnt vmcnt(0)
    s_barrier
    v_mfma_f32_16x16x32_bf16 v[72:75], v[104:107], v[124:127], v[72:75]
    ds_read_b128 v[216:219], v251 offset:10240
    v_mfma_f32_16x16x32_bf16 v[68:71], v[104:107], v[120:123], v[68:71]
    ds_read_b128 v[220:223], v251 offset:11264
    v_mfma_f32_16x16x32_bf16 v[140:143], a[248:251], a[192:195], v[140:143]
    ds_read_b64_tr_b16 a[204:205], v253 offset:47104
    v_cvt_pk_bf16_f32 v104, v136, v137
    v_mfma_f32_16x16x32_bf16 v[140:143], a[252:255], a[196:199], v[140:143]
    ds_read_b64_tr_b16 a[206:207], v253 offset:48384
    v_cvt_pk_bf16_f32 v105, v138, v139
    s_waitcnt lgkmcnt(6)
    v_mfma_f32_16x16x32_bf16 v[184:187], a[24:27], a[56:59], v[184:187]
    ds_read_b64_tr_b16 a[64:65], v247 offset:36864
    v_mfma_f32_16x16x32_bf16 v[184:187], a[28:31], a[60:63], v[184:187]
    ds_read_b64_tr_b16 a[66:67], v247 offset:38144
    v_mfma_f32_16x16x32_bf16 v[188:191], a[32:35], a[56:59], v[188:191]
    ds_read_b64_tr_b16 a[68:69], v247 offset:47104
    s_waitcnt lgkmcnt(6)
    v_xor_b32 v216, v224, v216
    v_mfma_f32_16x16x32_bf16 v[188:191], a[36:39], a[60:63], v[188:191]
    ds_read_b64_tr_b16 a[70:71], v247 offset:48384
    v_xor_b32 v218, v225, v218
    v_mfma_f32_16x16x32_bf16 v[144:147], a[224:227], a[96:99], 0
    ds_read_b64_tr_b16 a[104:105], v249 offset:0
    v_or_b32 v252, v216, v218
    v_mfma_f32_16x16x32_bf16 v[144:147], a[228:231], a[100:103], v[144:147]
    ds_read_b64_tr_b16 a[106:107], v249 offset:1280
    s_waitcnt lgkmcnt(6)
    v_xor_b32 v220, v224, v220
    v_mfma_f32_16x16x32_bf16 v[144:147], a[240:243], a[200:203], v[144:147]
    ds_read_b64_tr_b16 a[108:109], v249 offset:10240
    v_xor_b32 v222, v225, v222
    v_mfma_f32_16x16x32_bf16 v[144:147], a[244:247], a[204:207], v[144:147]
    ds_read_b64_tr_b16 a[110:111], v249 offset:11520
    v_or3_b32 v252, v252, v220, v222
    v_mfma_f32_16x16x32_bf16 v[148:151], a[232:235], a[96:99], 0
    ds_read_b64_tr_b16 a[208:209], v249 offset:36864
    v_and_b32 v252, 0xc000c000, v252
    v_mfma_f32_16x16x32_bf16 v[148:151], a[236:239], a[100:103], v[148:151]
    ds_read_b64_tr_b16 a[210:211], v249 offset:38144
    v_cmp_ne_u32 vcc, 0, v252
    s_nop 1
    s_cbranch_vccnz L_pslow7_1
L_pback7_1:
    v_cvt_pk_bf16_f32 v106, v140, v141
    v_cvt_pk_bf16_f32 v107, v142, v143
    v_cvt_pk_bf16_f32 v108, v184, v185
    v_cvt_pk_bf16_f32 v109, v186, v187
    v_cvt_pk_bf16_f32 v110, v188, v189
    v_cvt_pk_bf16_f32 v111, v190, v191
    s_nop 1
    v_mfma_f32_16x16x32_bf16 v[76:79], v[108:111], v[124:127], v[76:79]
    ds_read_b64_tr_b16 a[212:213], v249 offset:47104
    v_mfma_f32_16x16x32_bf16 v[40:43], v[108:111], v[120:123], v[40:43]
    ds_read_b64_tr_b16 a[214:215], v249 offset:48384
    v_mfma_f32_16x16x32_bf16 v[64:67], v[100:103], v[220:223], v[64:67]
    ds_read_b64_tr_b16 a[72:73], v248 offset:36896
    v_cvt_pk_bf16_f32 v108, v144, v145
    v_mfma_f32_16x16x32_bf16 v[60:63], v[100:103], v[216:219], v[60:63]
    ds_read_b64_tr_b16 a[74:75], v248 offset:38176
    v_cvt_pk_bf16_f32 v109, v146, v147
    v_mfma_f32_16x16x32_bf16 v[72:75], v[104:107], v[220:223], v[72:75]
    ds_read_b64_tr_b16 a[76:77], v248 offset:47136
    v_mfma_f32_16x16x32_bf16 v[68:71], v[104:107], v[216:219], v[68:71]
    ds_read_b64_tr_b16 a[78:79], v248 offset:48416
    v_mfma_f32_16x16x32_bf16 v[148:151], a[248:251], a[200:203], v[148:151]
    ds_read_b64_tr_b16 a[112:113], v250 offset:32
    v_cvt_pk_bf16_f32 v60, v60, v61
    v_mfma_f32_16x16x32_bf16 v[148:151], a[252:255], a[204:207], v[148:151]
    ds_read_b64_tr_b16 a[114:115], v250 offset:1312
    v_cvt_pk_bf16_f32 v61, v62, v63
    s_waitcnt lgkmcnt(6)
    v_mfma_f32_16x16x32_bf16 v[192:195], a[24:27], a[64:67], v[192:195]
    ds_read_b64_tr_b16 a[116:117], v250 offset:10272
    v_cvt_pk_bf16_f32 v62, v64, v65
    v_mfma_f32_16x16x32_bf16 v[192:195], a[28:31], a[68:71], v[192:195]
    ds_read_b64_tr_b16 a[118:119], v250 offset:11552
    v_cvt_pk_bf16_f32 v63, v66, v66
    v_mfma_f32_16x16x32_bf16 v[196:199], a[32:35], a[64:67], v[196:199]
    ds_read_b64_tr_b16 a[216:217], v250 offset:36896
    v_bfi_b32 v63, s99, v230, v63
    v_mfma_f32_16x16x32_bf16 v[196:199], a[36:39], a[68:71], v[196:199]
    ds_read_b64_tr_b16 a[218:219], v250 offset:38176
    buffer_store_dwordx4 v[60:63], v232, s[36:39], s95 offen offset:0 sc1
    v_mfma_f32_16x16x32_bf16 v[152:155], a[224:227], a[104:107], 0
    ds_read_b64_tr_b16 a[220:221], v250 offset:47136
    v_cvt_pk_bf16_f32 v64, v67, v68
    v_mfma_f32_16x16x32_bf16 v[152:155], a[228:231], a[108:111], v[152:155]
    ds_read_b64_tr_b16 a[222:223], v250 offset:48416
    v_cvt_pk_bf16_f32 v65, v69, v70
    v_cvt_pk_bf16_f32 v66, v71, v72
    v_cvt_pk_bf16_f32 v67, v73, v73
    v_bfi_b32 v67, s99, v230, v67
    buffer_store_dwordx4 v[64:67], v232, s[36:39], s95 offen offset:1024 sc1
    v_cvt_pk_bf16_f32 v68, v74, v75
    v_cvt_pk_bf16_f32 v110, v148, v149
    v_cvt_pk_bf16_f32 v111, v150, v151
    s_nop 1
    v_mfma_f32_16x16x32_bf16 v[76:79], v[108:111], v[220:223], v[76:79]
    ds_read_b128 a[8:11], v243 offset:36864
    v_cvt_pk_bf16_f32 v112, v192, v193
    v_mfma_f32_16x16x32_bf16 v[40:43], v[108:111], v[216:219], v[40:43]
    ds_read_b128 a[12:15], v244 offset:36864
    v_cvt_pk_bf16_f32 v113, v194, v195
    v_mfma_f32_16x16x32_bf16 v[152:155], a[240:243], a[208:211], v[152:155]
    ds_read_b128 a[16:19], v243 offset:38912
    v_cvt_pk_bf16_f32 v114, v196, v197
    v_mfma_f32_16x16x32_bf16 v[152:155], a[244:247], a[212:215], v[152:155]
    ds_read_b128 a[20:23], v244 offset:38912
    v_cvt_pk_bf16_f32 v115, v198, v199
    s_nop 1
    v_mfma_f32_16x16x32_bf16 v[48:51], v[112:115], v[124:127], v[48:51]
    ds_read_b128 a[144:147], v245 offset:0
    v_cvt_pk_bf16_f32 v69, v76, v77
    v_mfma_f32_16x16x32_bf16 v[44:47], v[112:115], v[120:123], v[44:47]
    ds_read_b128 a[148:151], v246 offset:0
    v_cvt_pk_bf16_f32 v70, v78, v79
    v_mfma_f32_16x16x32_bf16 v[156:159], a[232:235], a[104:107], 0
    ds_read_b128 a[152:155], v245 offset:2048
    v_mov_b32 v71, v230
    v_mfma_f32_16x16x32_bf16 v[156:159], a[236:239], a[108:111], v[156:159]
    ds_read_b128 a[156:159], v246 offset:2048
    buffer_store_dwordx4 v[68:71], v232, s[36:39], s95 offen offset:2048 sc1
    v_mfma_f32_16x16x32_bf16 v[156:159], a[248:251], a[208:211], v[156:159]
    v_cvt_pk_bf16_f32 v40, v40, v41
    v_cvt_pk_bf16_f32 v41, v42, v43
    v_mfma_f32_16x16x32_bf16 v[156:159], a[252:255], a[212:215], v[156:159]
    v_cvt_pk_bf16_f32 v112, v152, v153
    v_cvt_pk_bf16_f32 v113, v154, v155
    s_waitcnt lgkmcnt(6)
    v_mfma_f32_16x16x32_bf16 v[200:203], a[24:27], a[72:75], v[200:203]
    v_xor_b32 v208, v224, v208
    v_xor_b32 v210, v225, v210
    v_mfma_f32_16x16x32_bf16 v[200:203], a[28:31], a[76:79], v[200:203]
    v_or_b32 v252, v208, v210
    v_xor_b32 v212, v224, v212
    v_mfma_f32_16x16x32_bf16 v[204:207], a[32:35], a[72:75], v[204:207]
    v_xor_b32 v214, v225, v214
    v_or3_b32 v252, v252, v212, v214
    v_mfma_f32_16x16x32_bf16 v[204:207], a[36:39], a[76:79], v[204:207]
    v_and_b32 v252, 0xc000c000, v252
    v_cmp_ne_u32 vcc, 0, v252
    v_mfma_f32_16x16x32_bf16 v[160:163], a[224:227], a[112:115], 0
    s_nop 0
    s_cbranch_vccnz L_pslow5_0
L_pback5_0:
    v_cvt_pk_bf16_f32 v114, v156, v157
    v_mfma_f32_16x16x32_bf16 v[160:163], a[228:231], a[116:119], v[160:163]
    ds_read_b128 a[24:27], v245 offset:36864
    v_cvt_pk_bf16_f32 v115, v158, v159
    s_nop 1
    v_mfma_f32_16x16x32_bf16 v[48:51], v[112:115], v[220:223], v[48:51]
    ds_read_b128 a[28:31], v246 offset:36864
    v_cvt_pk_bf16_f32 v116, v200, v201
    v_mfma_f32_16x16x32_bf16 v[44:47], v[112:115], v[216:219], v[44:47]
    ds_read_b128 a[32:35], v245 offset:38912
    v_cvt_pk_bf16_f32 v117, v202, v203
    v_mfma_f32_16x16x32_bf16 v[160:163], a[240:243], a[216:219], v[160:163]
    ds_read_b128 a[36:39], v246 offset:38912
    v_cvt_pk_bf16_f32 v118, v204, v205
    v_mfma_f32_16x16x32_bf16 v[160:163], a[244:247], a[220:223], v[160:163]
    v_cvt_pk_bf16_f32 v119, v206, v207
    s_nop 1
    v_mfma_f32_16x16x32_bf16 v[56:59], v[116:119], v[124:127], v[56:59]
    v_cvt_pk_bf16_f32 v42, v44, v45
    v_cvt_pk_bf16_f32 v43, v46, v46
    v_mfma_f32_16x16x32_bf16 v[52:55], v[116:119], v[120:123], v[52:55]
    v_bfi_b32 v43, s99, v230, v43
    buffer_store_dwordx4 v[40:43], v232, s[36:39], s94 offen offset:0 sc1
    v_mfma_f32_16x16x32_bf16 v[164:167], a[232:235], a[112:115], 0
    v_cvt_pk_bf16_f32 v44, v47, v48
    v_cvt_pk_bf16_f32 v45, v49, v50
    v_mfma_f32_16x16x32_bf16 v[164:167], a[236:239], a[116:119], v[164:167]
    ds_read_b128 v[120:123], v251 offset:0
    v_cvt_pk_bf16_f32 v116, v160, v161
    v_mfma_f32_16x16x32_bf16 v[164:167], a[248:251], a[216:219], v[164:167]
    ds_read_b128 v[124:127], v251 offset:1024
    v_cvt_pk_bf16_f32 v117, v162, v163
    v_mfma_f32_16x16x32_bf16 v[164:167], a[252:255], a[220:223], v[164:167]
    v_mfma_f32_16x16x32_bf16 v[24:27], v[80:83], v[212:215], v[24:27]
    v_mfma_f32_16x16x32_bf16 v[20:23], v[80:83], v[208:211], v[20:23]
    s_nop 0
    s_nop 0
    v_mfma_f32_16x16x32_bf16 v[32:35], v[84:87], v[212:215], v[32:35]
    s_nop 0
    s_nop 0
    v_mfma_f32_16x16x32_bf16 v[28:31], v[84:87], v[208:211], v[28:31]
    v_cvt_pk_bf16_f32 v118, v164, v165
    v_cvt_pk_bf16_f32 v119, v166, v167
    v_mfma_f32_16x16x32_bf16 v[36:39], v[88:91], v[212:215], v[36:39]
    s_waitcnt lgkmcnt(1)
    v_xor_b32 v120, v224, v120
    v_xor_b32 v122, v225, v122
    v_mfma_f32_16x16x32_bf16 v[0:3], v[88:91], v[208:211], v[0:3]
    v_or_b32 v252, v120, v122
    s_waitcnt lgkmcnt(0)
    v_xor_b32 v124, v224, v124
    v_mfma_f32_16x16x32_bf16 v[56:59], v[116:119], v[220:223], v[56:59]
    v_xor_b32 v126, v225, v126
    v_or3_b32 v252, v252, v124, v126
    v_mfma_f32_16x16x32_bf16 v[52:55], v[116:119], v[216:219], v[52:55]
    v_and_b32 v252, 0xc000c000, v252
    v_cmp_ne_u32 vcc, 0, v252
    v_mfma_f32_16x16x32_bf16 v[8:11], v[92:95], v[212:215], v[8:11]
    s_nop 0
    s_cbranch_vccnz L_pslow6_0
L_pback6_0:
    v_mfma_f32_16x16x32_bf16 v[4:7], v[92:95], v[208:211], v[4:7]
    ds_read_b128 v[216:219], v251 offset:8192
    v_mfma_f32_16x16x32_bf16 v[16:19], v[96:99], v[212:215], v[16:19]
    ds_read_b128 v[220:223], v251 offset:9216
    v_cvt_pk_bf16_f32 v46, v51, v52
    v_mfma_f32_16x16x32_bf16 v[12:15], v[96:99], v[208:211], v[12:15]
    v_cvt_pk_bf16_f32 v47, v53, v53
    v_bfi_b32 v47, s99, v230, v47
    v_mfma_f32_16x16x32_bf16 v[136:139], a[128:131], a[160:163], 0
    buffer_store_dwordx4 v[44:47], v232, s[36:39], s94 offen offset:1024 sc1
    v_cvt_pk_bf16_f32 v48, v54, v55
    v_mfma_f32_16x16x32_bf16 v[136:139], a[132:135], a[164:167], v[136:139]
    v_cvt_pk_bf16_f32 v49, v56, v57
    v_cvt_pk_bf16_f32 v50, v58, v59
    v_mfma_f32_16x16x32_bf16 v[136:139], a[8:11], a[40:43], v[136:139]
    v_mov_b32 v51, v230
    buffer_store_dwordx4 v[48:51], v232, s[36:39], s94 offen offset:2048 sc1
    v_mfma_f32_16x16x32_bf16 v[136:139], a[12:15], a[44:47], v[136:139]
    v_mfma_f32_16x16x32_bf16 v[140:143], a[136:139], a[160:163], 0
    s_waitcnt lgkmcnt(1)
    v_xor_b32 v216, v224, v216
    v_xor_b32 v218, v225, v218
    v_mfma_f32_16x16x32_bf16 v[140:143], a[140:143], a[164:167], v[140:143]
    v_or_b32 v252, v216, v218
    s_waitcnt lgkmcnt(0)
    v_xor_b32 v220, v224, v220
    v_mfma_f32_16x16x32_bf16 v[140:143], a[16:19], a[40:43], v[140:143]
    v_xor_b32 v222, v225, v222
    v_or3_b32 v252, v252, v220, v222
    v_mfma_f32_16x16x32_bf16 v[140:143], a[20:23], a[44:47], v[140:143]
    v_and_b32 v252, 0xc000c000, v252
    v_cmp_ne_u32 vcc, 0, v252
    v_mfma_f32_16x16x32_bf16 v[144:147], a[144:147], a[80:83], 0
    s_nop 0
    s_cbranch_vccnz L_pslow7_0
L_pback7_0:
    v_cvt_pk_bf16_f32 v80, v136, v137
    v_mfma_f32_16x16x32_bf16 v[144:147], a[148:151], a[84:87], v[144:147]
    v_cvt_pk_bf16_f32 v81, v138, v139
    v_mfma_f32_16x16x32_bf16 v[144:147], a[24:27], a[120:123], v[144:147]
    v_mfma_f32_16x16x32_bf16 v[144:147], a[28:31], a[124:127], v[144:147]
    v_cvt_pk_bf16_f32 v82, v140, v141
    v_cvt_pk_bf16_f32 v83, v142, v143
    v_mfma_f32_16x16x32_bf16 v[148:151], a[152:155], a[80:83], 0
    v_mfma_f32_16x16x32_bf16 v[148:151], a[156:159], a[84:87], v[148:151]
    v_mfma_f32_16x16x32_bf16 v[24:27], v[80:83], v[124:127], v[24:27]
    s_nop 0
    s_nop 0
    v_mfma_f32_16x16x32_bf16 v[20:23], v[80:83], v[120:123], v[20:23]
    v_cvt_pk_bf16_f32 v100, v144, v145
    v_cvt_pk_bf16_f32 v101, v146, v147
    v_mfma_f32_16x16x32_bf16 v[148:151], a[32:35], a[120:123], v[148:151]
    v_mfma_f32_16x16x32_bf16 v[148:151], a[36:39], a[124:127], v[148:151]
    v_mfma_f32_16x16x32_bf16 v[152:155], a[128:131], a[168:171], 0
    v_mfma_f32_16x16x32_bf16 v[152:155], a[132:135], a[172:175], v[152:155]
    s_nop 0
    s_nop 0
    v_mfma_f32_16x16x32_bf16 v[152:155], a[8:11], a[48:51], v[152:155]
    v_lshrrev_b32 v238, 8, v232
    v_min_u32 v239, 2, v238
    v_mfma_f32_16x16x32_bf16 v[152:155], a[12:15], a[52:55], v[152:155]
    v_cvt_pk_bf16_f32 v102, v148, v149
    v_cvt_pk_bf16_f32 v103, v150, v151
    v_mfma_f32_16x16x32_bf16 v[156:159], a[136:139], a[168:171], 0
    v_mul_u32_u24 v239, 12288, v239
    v_and_b32 v240, 48, v232
    v_mfma_f32_16x16x32_bf16 v[156:159], a[140:143], a[172:175], v[156:159]
    v_add_u32 v239, v239, v240
    v_add_u32 v236, 2060, v239
    v_mfma_f32_16x16x32_bf16 v[24:27], v[100:103], v[220:223], v[24:27]
    v_min_u32 v239, 1, v238
    v_xor_b32 v239, 1, v239
    v_mfma_f32_16x16x32_bf16 v[20:23], v[100:103], v[216:219], v[20:23]
    v_mul_i32_i24 v239, -1024, v239
    v_add_u32 v236, v236, v239
    v_mfma_f32_16x16x32_bf16 v[156:159], a[16:19], a[48:51], v[156:159]
    v_cvt_pk_bf16_f32 v84, v152, v153
    v_cvt_pk_bf16_f32 v85, v154, v155
    v_mfma_f32_16x16x32_bf16 v[156:159], a[20:23], a[52:55], v[156:159]
    v_bfe_u32 v239, v232, 4, 4
    v_mul_u32_u24 v239, 208, v239
    v_mfma_f32_16x16x32_bf16 v[160:163], a[144:147], a[88:91], 0
    v_cvt_pk_bf16_f32 v20, v20, v21
    v_cvt_pk_bf16_f32 v21, v22, v23
    v_mfma_f32_16x16x32_bf16 v[160:163], a[148:151], a[92:95], v[160:163]
    v_cvt_pk_bf16_f32 v22, v24, v25
    v_cvt_pk_bf16_f32 v23, v26, v26
    v_mfma_f32_16x16x32_bf16 v[160:163], a[24:27], a[192:195], v[160:163]
    v_bfi_b32 v23, s99, v230, v23
    buffer_store_dwordx4 v[20:23], v232, s[36:39], s93 offen offset:0 sc1
    v_mfma_f32_16x16x32_bf16 v[160:163], a[28:31], a[196:199], v[160:163]
    v_cvt_pk_bf16_f32 v86, v156, v157
    v_cvt_pk_bf16_f32 v87, v158, v159
    v_mfma_f32_16x16x32_bf16 v[164:167], a[152:155], a[88:91], 0
    v_mfma_f32_16x16x32_bf16 v[164:167], a[156:159], a[92:95], v[164:167]
    v_mfma_f32_16x16x32_bf16 v[32:35], v[84:87], v[124:127], v[32:35]
    s_nop 0
    s_nop 0
    v_mfma_f32_16x16x32_bf16 v[28:31], v[84:87], v[120:123], v[28:31]
    v_cvt_pk_bf16_f32 v104, v160, v161
    v_cvt_pk_bf16_f32 v105, v162, v163
L_pad7:
    s_cbranch_execz L_hop2
    v_mfma_f32_16x16x32_bf16 v[164:167], a[32:35], a[192:195], v[164:167]
    v_mfma_f32_16x16x32_bf16 v[164:167], a[36:39], a[196:199], v[164:167]
    v_mfma_f32_16x16x32_bf16 v[128:131], a[128:131], a[176:179], 0
    v_lshl_add_u32 v234, v238, 3, v239
    v_mfma_f32_16x16x32_bf16 v[128:131], a[132:135], a[180:183], v[128:131]
    s_mul_i32 s3, s77, 6656
    v_mfma_f32_16x16x32_bf16 v[128:131], a[8:11], a[56:59], v[128:131]
    s_lshl_b32 s6, s78, 5
    v_mfma_f32_16x16x32_bf16 v[128:131], a[12:15], a[60:63], v[128:131]
    s_nop 0
    v_cvt_pk_bf16_f32 v106, v164, v165
    v_cvt_pk_bf16_f32 v107, v166, v167
    v_mfma_f32_16x16x32_bf16 v[132:135], a[136:139], a[176:179], 0
    s_add_u32 s3, s3, s6
    v_add_u32 v234, s3, v234
    v_mfma_f32_16x16x32_bf16 v[132:135], a[140:143], a[180:183], v[132:135]
    v_lshrrev_b32 v239, 7, v232
    v_mfma_f32_16x16x32_bf16 v[32:35], v[104:107], v[220:223], v[32:35]
    v_and_b32 v240, 0x70, v232
    v_mfma_f32_16x16x32_bf16 v[28:31], v[104:107], v[216:219], v[28:31]
    v_cvt_pk_bf16_f32 v88, v128, v129
    v_cvt_pk_bf16_f32 v89, v130, v131
    v_mfma_f32_16x16x32_bf16 v[132:135], a[16:19], a[56:59], v[132:135]
    v_mul_u32_u24 v241, 2560, v239
    v_add_u32 v241, v241, v240
    v_mfma_f32_16x16x32_bf16 v[132:135], a[20:23], a[60:63], v[132:135]
    v_mul_u32_u24 v235, 208, v239
    v_mfma_f32_16x16x32_bf16 v[136:139], a[144:147], a[96:99], 0
    v_cvt_pk_bf16_f32 v24, v27, v28
    v_cvt_pk_bf16_f32 v25, v29, v30
    v_mfma_f32_16x16x32_bf16 v[136:139], a[148:151], a[100:103], v[136:139]
    v_cvt_pk_bf16_f32 v26, v31, v32
    v_cvt_pk_bf16_f32 v27, v33, v33
    v_mfma_f32_16x16x32_bf16 v[136:139], a[24:27], a[200:203], v[136:139]
    v_bfi_b32 v27, s99, v230, v27
    buffer_store_dwordx4 v[24:27], v232, s[36:39], s93 offen offset:1024 sc1
    v_mfma_f32_16x16x32_bf16 v[136:139], a[28:31], a[204:207], v[136:139]
    v_cvt_pk_bf16_f32 v28, v34, v35
    v_add_u32 v235, v235, v240
    v_mfma_f32_16x16x32_bf16 v[140:143], a[152:155], a[96:99], 0
    s_mul_i32 s3, s72, 3328
    v_add_u32 v235, s3, v235
    v_mfma_f32_16x16x32_bf16 v[140:143], a[156:159], a[100:103], v[140:143]
    v_cvt_pk_bf16_f32 v90, v132, v133
    v_cvt_pk_bf16_f32 v91, v134, v135
    s_nop 1
    v_mfma_f32_16x16x32_bf16 v[36:39], v[88:91], v[124:127], v[36:39]
    v_bfe_u32 v239, v232, 6, 3
    v_and_b32 v240, 0x30, v232
    v_mfma_f32_16x16x32_bf16 v[0:3], v[88:91], v[120:123], v[0:3]
    v_mul_u32_u24 v242, 2560, v239
    v_add_u32 v242, v242, v240
    v_mfma_f32_16x16x32_bf16 v[140:143], a[32:35], a[200:203], v[140:143]
    v_cvt_pk_bf16_f32 v108, v136, v137
    v_cvt_pk_bf16_f32 v109, v138, v139
    v_mfma_f32_16x16x32_bf16 v[140:143], a[36:39], a[204:207], v[140:143]
    v_lshrrev_b32 v237, 9, v232
    v_lshl_add_u32 v242, v237, 28, v242
    v_mfma_f32_16x16x32_bf16 v[144:147], a[128:131], a[184:187], 0
    v_mul_u32_u24 v237, 208, v239
    v_add_u32 v237, v237, v240
    v_mfma_f32_16x16x32_bf16 v[144:147], a[132:135], a[188:191], v[144:147]
    s_mul_i32 s3, s77, 6656
    v_mfma_f32_16x16x32_bf16 v[144:147], a[8:11], a[64:67], v[144:147]
    s_mul_i32 s6, s78, 1664
    v_mfma_f32_16x16x32_bf16 v[144:147], a[12:15], a[68:71], v[144:147]
    v_cvt_pk_bf16_f32 v110, v140, v141
    v_cvt_pk_bf16_f32 v111, v142, v143
    v_mfma_f32_16x16x32_bf16 v[148:151], a[136:139], a[184:187], 0
    s_add_u32 s3, s3, s6
    v_add_u32 v237, s3, v237
    v_mfma_f32_16x16x32_bf16 v[148:151], a[140:143], a[188:191], v[148:151]
    s_lshl_b32 s3, s78, 6
    v_mfma_f32_16x16x32_bf16 v[36:39], v[108:111], v[220:223], v[36:39]
    s_cmp_eq_u32 s78, 0
    s_cselect_b32 s73, s73, s75
    v_mfma_f32_16x16x32_bf16 v[0:3], v[108:111], v[216:219], v[0:3]
    v_cvt_pk_bf16_f32 v92, v144, v145
    v_cvt_pk_bf16_f32 v93, v146, v147
    v_mfma_f32_16x16x32_bf16 v[148:151], a[16:19], a[64:67], v[148:151]
    s_sub_u32 s73, s73, s3
    s_add_u32 s75, s73, 20480
    v_mfma_f32_16x16x32_bf16 v[148:151], a[20:23], a[68:71], v[148:151]
    s_mul_i32 s3, s78, 20448
    v_mfma_f32_16x16x32_bf16 v[152:155], a[144:147], a[104:107], 0
    v_cvt_pk_bf16_f32 v29, v36, v37
    v_cvt_pk_bf16_f32 v30, v38, v39
    v_mfma_f32_16x16x32_bf16 v[152:155], a[148:151], a[108:111], v[152:155]
    v_mov_b32 v31, v230
    buffer_store_dwordx4 v[28:31], v232, s[36:39], s93 offen offset:2048 sc1
    v_mfma_f32_16x16x32_bf16 v[152:155], a[24:27], a[208:211], v[152:155]
    s_add_u32 s97, s97, s3
    s_lshl_b32 s6, s78, 5
    v_mfma_f32_16x16x32_bf16 v[152:155], a[28:31], a[212:215], v[152:155]
    v_cvt_pk_bf16_f32 v94, v148, v149
    v_cvt_pk_bf16_f32 v95, v150, v151
    v_mfma_f32_16x16x32_bf16 v[156:159], a[152:155], a[104:107], 0
    v_mfma_f32_16x16x32_bf16 v[156:159], a[156:159], a[108:111], v[156:159]
    v_mfma_f32_16x16x32_bf16 v[8:11], v[92:95], v[124:127], v[8:11]
    s_nop 0
    s_nop 0
    v_mfma_f32_16x16x32_bf16 v[4:7], v[92:95], v[120:123], v[4:7]
    v_cvt_pk_bf16_f32 v112, v152, v153
    v_cvt_pk_bf16_f32 v113, v154, v155
    v_mfma_f32_16x16x32_bf16 v[156:159], a[32:35], a[208:211], v[156:159]
    v_mfma_f32_16x16x32_bf16 v[156:159], a[36:39], a[212:215], v[156:159]
    v_mfma_f32_16x16x32_bf16 v[160:163], a[128:131], a[0:3], 0
    v_mfma_f32_16x16x32_bf16 v[160:163], a[132:135], a[4:7], v[160:163]
    s_nop 0
    s_nop 0
    v_mfma_f32_16x16x32_bf16 v[160:163], a[8:11], a[72:75], v[160:163]
    s_nop 0
    s_nop 0
    v_mfma_f32_16x16x32_bf16 v[160:163], a[12:15], a[76:79], v[160:163]
    v_cvt_pk_bf16_f32 v114, v156, v157
    v_cvt_pk_bf16_f32 v115, v158, v159
    v_mfma_f32_16x16x32_bf16 v[164:167], a[136:139], a[0:3], 0
    v_mfma_f32_16x16x32_bf16 v[164:167], a[140:143], a[4:7], v[164:167]
    v_mfma_f32_16x16x32_bf16 v[8:11], v[112:115], v[220:223], v[8:11]
    s_nop 0
    s_nop 0
    v_mfma_f32_16x16x32_bf16 v[4:7], v[112:115], v[216:219], v[4:7]
    v_cvt_pk_bf16_f32 v96, v160, v161
    v_cvt_pk_bf16_f32 v97, v162, v163
    v_mfma_f32_16x16x32_bf16 v[164:167], a[16:19], a[72:75], v[164:167]
    v_mfma_f32_16x16x32_bf16 v[164:167], a[20:23], a[76:79], v[164:167]
    v_mfma_f32_16x16x32_bf16 v[128:131], a[144:147], a[112:115], 0
    v_mfma_f32_16x16x32_bf16 v[128:131], a[148:151], a[116:119], v[128:131]
    s_nop 0
    s_nop 0
    v_mfma_f32_16x16x32_bf16 v[128:131], a[24:27], a[216:219], v[128:131]
    s_nop 0
    s_nop 0
    v_mfma_f32_16x16x32_bf16 v[128:131], a[28:31], a[220:223], v[128:131]
    v_cvt_pk_bf16_f32 v98, v164, v165
    v_cvt_pk_bf16_f32 v99, v166, v167
    v_mfma_f32_16x16x32_bf16 v[132:135], a[152:155], a[112:115], 0
    v_mfma_f32_16x16x32_bf16 v[132:135], a[156:159], a[116:119], v[132:135]
    v_mfma_f32_16x16x32_bf16 v[16:19], v[96:99], v[124:127], v[16:19]
    s_nop 0
    s_nop 0
    v_mfma_f32_16x16x32_bf16 v[12:15], v[96:99], v[120:123], v[12:15]
    v_cvt_pk_bf16_f32 v116, v128, v129
    v_cvt_pk_bf16_f32 v117, v130, v131
    v_mfma_f32_16x16x32_bf16 v[132:135], a[32:35], a[216:219], v[132:135]
    v_mfma_f32_16x16x32_bf16 v[132:135], a[36:39], a[220:223], v[132:135]
    s_nop 7
    v_cvt_pk_bf16_f32 v118, v132, v133
    v_cvt_pk_bf16_f32 v119, v134, v135
    s_nop 1
    v_mfma_f32_16x16x32_bf16 v[16:19], v[116:119], v[220:223], v[16:19]
    v_mfma_f32_16x16x32_bf16 v[12:15], v[116:119], v[216:219], v[12:15]
    v_xor_b32 v228, v230, v255
    v_cmp_lt_u32 vcc, 0xffff, v228
    s_nop 1
    s_cmp_eq_u32 s88, 3
    s_cbranch_scc1 L_nee
    s_cmp_gt_u32 s88, 0
    s_cbranch_scc1 L_nee_3
    s_and_b32 s100, vcc_hi, 0xffff
    s_cbranch_scc1 L_nee
    buffer_load_dwordx4 v[192:195], v232, s[36:39], s5 offen offset:0 sc1
    buffer_load_dwordx4 v[196:199], v232, s[36:39], s5 offen offset:1024 sc1
    buffer_load_dwordx4 v[200:203], v232, s[36:39], s5 offen offset:2048 sc1
    s_mov_b32 s88, 1
L_nee_3:
    s_cmp_gt_u32 s88, 1
    s_cbranch_scc1 L_nee_2
    s_and_b32 s100, vcc_lo, 0xffff0000
    s_cbranch_scc1 L_nee
    buffer_load_dwordx4 v[180:183], v232, s[36:39], s4 offen offset:0 sc1
    buffer_load_dwordx4 v[184:187], v232, s[36:39], s4 offen offset:1024 sc1
    buffer_load_dwordx4 v[188:191], v232, s[36:39], s4 offen offset:2048 sc1
    s_mov_b32 s88, 2
L_nee_2:
    s_and_b32 s100, vcc_lo, 0xffff
    s_cbranch_scc1 L_nee
    buffer_load_dwordx4 v[168:171], v232, s[36:39], s96 offen offset:0 sc1
    buffer_load_dwordx4 v[172:175], v232, s[36:39], s96 offen offset:1024 sc1
    buffer_load_dwordx4 v[176:179], v232, s[36:39], s96 offen offset:2048 sc1
    s_mov_b32 s88, 3
L_nee:
    s_mov_b32 s7, 0
L_pwA:
    s_cmp_ge_u32 s88, 2
    s_cbranch_scc1 L_pgA
    buffer_load_dword v255, v236, s[36:39], s96 offen sc1
    s_waitcnt vmcnt(0)
    v_xor_b32 v228, v230, v255
    v_cmp_lt_u32 vcc, 0xffff, v228
    s_add_u32 s7, s7, 1
    s_cmp_lt_u32 s7, 20000
    s_cbranch_scc1 L_pcA
    s_mov_b64 vcc, 0
L_pcA:
    s_cmp_gt_u32 s88, 0
    s_cbranch_scc1 L_pfA_3
    s_and_b32 s100, vcc_hi, 0xffff
    s_cbranch_scc1 L_pfA
    buffer_load_dwordx4 v[192:195], v232, s[36:39], s5 offen offset:0 sc1
    buffer_load_dwordx4 v[196:199], v232, s[36:39], s5 offen offset:1024 sc1
    buffer_load_dwordx4 v[200:203], v232, s[36:39], s5 offen offset:2048 sc1
    s_mov_b32 s88, 1
L_pfA_3:
    s_cmp_gt_u32 s88, 1
    s_cbranch_scc1 L_pfA_2
    s_and_b32 s100, vcc_lo, 0xffff0000
    s_cbranch_scc1 L_pfA
    buffer_load_dwordx4 v[180:183], v232, s[36:39], s4 offen offset:0 sc1
    buffer_load_dwordx4 v[184:187], v232, s[36:39], s4 offen offset:1024 sc1
    buffer_load_dwordx4 v[188:191], v232, s[36:39], s4 offen offset:2048 sc1
    s_mov_b32 s88, 2
L_pfA_2:
    s_and_b32 s100, vcc_lo, 0xffff
    s_cbranch_scc1 L_pfA
    buffer_load_dwordx4 v[168:171], v232, s[36:39], s96 offen offset:0 sc1
    buffer_load_dwordx4 v[172:175], v232, s[36:39], s96 offen offset:1024 sc1
    buffer_load_dwordx4 v[176:179], v232, s[36:39], s96 offen offset:2048 sc1
    s_mov_b32 s88, 3
L_pfA:
    s_branch L_pwA
L_pgA:
    s_cmp_eq_u32 s88, 3
    s_cbranch_scc1 L_allin
    buffer_load_dword v255, v236, s[36:39], s96 offen sc1
    s_waitcnt vmcnt(0)
    v_xor_b32 v228, v230, v255
    v_cmp_lt_u32 vcc, 0xffff, v228
    s_nop 1
    s_cmp_gt_u32 s88, 0
    s_cbranch_scc1 L_allin_3
    s_and_b32 s100, vcc_hi, 0xffff
    s_cbranch_scc1 L_allin
    buffer_load_dwordx4 v[192:195], v232, s[36:39], s5 offen offset:0 sc1
    buffer_load_dwordx4 v[196:199], v232, s[36:39], s5 offen offset:1024 sc1
    buffer_load_dwordx4 v[200:203], v232, s[36:39], s5 offen offset:2048 sc1
    s_mov_b32 s88, 1
L_allin_3:
    s_cmp_gt_u32 s88, 1
    s_cbranch_scc1 L_allin_2
    s_and_b32 s100, vcc_lo, 0xffff0000
    s_cbranch_scc1 L_allin
    buffer_load_dwordx4 v[180:183], v232, s[36:39], s4 offen offset:0 sc1
    buffer_load_dwordx4 v[184:187], v232, s[36:39], s4 offen offset:1024 sc1
    buffer_load_dwordx4 v[188:191], v232, s[36:39], s4 offen offset:2048 sc1
    s_mov_b32 s88, 2
L_allin_2:
    s_and_b32 s100, vcc_lo, 0xffff
    s_cbranch_scc1 L_allin
    buffer_load_dwordx4 v[168:171], v232, s[36:39], s96 offen offset:0 sc1
    buffer_load_dwordx4 v[172:175], v232, s[36:39], s96 offen offset:1024 sc1
    buffer_load_dwordx4 v[176:179], v232, s[36:39], s96 offen offset:2048 sc1
    s_mov_b32 s88, 3
L_allin:
    s_waitcnt vmcnt(3)
    v_xor_b32 v252, v230, v195
    v_xor_b32 v228, v230, v199
    v_xor_b32 v231, v230, v203
    v_or3_b32 v252, v252, v228, v231
    v_cmp_lt_u32 vcc, 0xffff, v252
    s_nop 4
    s_cbranch_vccnz L_rslow3
L_rback3:
    v_lshlrev_b32 v224, 16, v201
    v_and_b32 v225, s99, v201
    v_pk_add_f32 v[0:1], v[0:1], v[224:225]
    v_lshlrev_b32 v226, 16, v202
    v_and_b32 v227, s99, v202
    v_pk_add_f32 v[2:3], v[2:3], v[226:227]
    v_lshlrev_b32 v224, 16, v194
    v_and_b32 v225, s99, v194
    v_pk_add_f32 v[4:5], v[4:5], v[224:225]
    v_lshlrev_b32 v226, 16, v195
    v_lshlrev_b32 v227, 16, v196
    v_pk_add_f32 v[6:7], v[6:7], v[226:227]
    v_and_b32 v224, s99, v198
    v_lshlrev_b32 v225, 16, v199
    v_pk_add_f32 v[12:13], v[12:13], v[224:225]
    v_lshlrev_b32 v226, 16, v200
    v_and_b32 v227, s99, v200
    v_pk_add_f32 v[14:15], v[14:15], v[226:227]
    v_lshlrev_b32 v224, 16, v192
    v_and_b32 v225, s99, v192
    v_pk_add_f32 v[8:9], v[8:9], v[224:225]
    v_lshlrev_b32 v226, 16, v193
    v_and_b32 v227, s99, v193
    v_pk_add_f32 v[10:11], v[10:11], v[226:227]
    v_and_b32 v224, s99, v196
    v_lshlrev_b32 v225, 16, v197
    v_pk_add_f32 v[16:17], v[16:17], v[224:225]
    v_and_b32 v226, s99, v197
    v_lshlrev_b32 v227, 16, v198
    v_pk_add_f32 v[18:19], v[18:19], v[226:227]
    v_xor_b32 v252, v230, v183
    v_xor_b32 v228, v230, v187
    v_xor_b32 v231, v230, v191
    v_or3_b32 v252, v252, v228, v231
    v_cmp_lt_u32 vcc, 0xffff, v252
    s_nop 4
    s_cbranch_vccnz L_rslow2
L_rback2:
    v_lshlrev_b32 v224, 16, v180
    v_and_b32 v225, s99, v180
    v_pk_add_f32 v[0:1], v[0:1], v[224:225]
    v_lshlrev_b32 v226, 16, v181
    v_and_b32 v227, s99, v181
    v_pk_add_f32 v[2:3], v[2:3], v[226:227]
    v_lshlrev_b32 v224, 16, v182
    v_and_b32 v225, s99, v182
    v_pk_add_f32 v[4:5], v[4:5], v[224:225]
    v_lshlrev_b32 v226, 16, v183
    v_lshlrev_b32 v227, 16, v184
    v_pk_add_f32 v[6:7], v[6:7], v[226:227]
    v_and_b32 v224, s99, v186
    v_lshlrev_b32 v225, 16, v187
    v_pk_add_f32 v[12:13], v[12:13], v[224:225]
    v_lshlrev_b32 v226, 16, v188
    v_and_b32 v227, s99, v188
    v_pk_add_f32 v[14:15], v[14:15], v[226:227]
    v_and_b32 v224, s99, v184
    v_lshlrev_b32 v225, 16, v185
    v_pk_add_f32 v[8:9], v[8:9], v[224:225]
    v_and_b32 v226, s99, v185
    v_lshlrev_b32 v227, 16, v186
    v_pk_add_f32 v[10:11], v[10:11], v[226:227]
    v_lshlrev_b32 v224, 16, v189
    v_and_b32 v225, s99, v189
    v_pk_add_f32 v[16:17], v[16:17], v[224:225]
    v_lshlrev_b32 v226, 16, v190
    v_and_b32 v227, s99, v190
    v_pk_add_f32 v[18:19], v[18:19], v[226:227]
    s_mov_b32 s7, 0
L_pwB:
    s_cmp_ge_u32 s88, 3
    s_cbranch_scc1 L_pgB
    buffer_load_dword v255, v236, s[36:39], s96 offen sc1
    s_waitcnt vmcnt(0)
    v_xor_b32 v228, v230, v255
    v_cmp_lt_u32 vcc, 0xffff, v228
    s_add_u32 s7, s7, 1
    s_cmp_lt_u32 s7, 20000
    s_cbranch_scc1 L_pcB
    s_mov_b64 vcc, 0
L_pcB:
    s_cmp_gt_u32 s88, 0
    s_cbranch_scc1 L_pfB_3
    s_and_b32 s100, vcc_hi, 0xffff
    s_cbranch_scc1 L_pfB
    buffer_load_dwordx4 v[192:195], v232, s[36:39], s5 offen offset:0 sc1
    buffer_load_dwordx4 v[196:199], v232, s[36:39], s5 offen offset:1024 sc1
    buffer_load_dwordx4 v[200:203], v232, s[36:39], s5 offen offset:2048 sc1
    s_mov_b32 s88, 1
L_pfB_3:
    s_cmp_gt_u32 s88, 1
    s_cbranch_scc1 L_pfB_2
    s_and_b32 s100, vcc_lo, 0xffff0000
    s_cbranch_scc1 L_pfB
    buffer_load_dwordx4 v[180:183], v232, s[36:39], s4 offen offset:0 sc1
    buffer_load_dwordx4 v[184:187], v232, s[36:39], s4 offen offset:1024 sc1
    buffer_load_dwordx4 v[188:191], v232, s[36:39], s4 offen offset:2048 sc1
    s_mov_b32 s88, 2
L_pfB_2:
    s_and_b32 s100, vcc_lo, 0xffff
    s_cbranch_scc1 L_pfB
    buffer_load_dwordx4 v[168:171], v232, s[36:39], s96 offen offset:0 sc1
    buffer_load_dwordx4 v[172:175], v232, s[36:39], s96 offen offset:1024 sc1
    buffer_load_dwordx4 v[176:179], v232, s[36:39], s96 offen offset:2048 sc1
    s_mov_b32 s88, 3
L_pfB:
    s_branch L_pwB
L_pgB:
    s_waitcnt vmcnt(0)
    v_xor_b32 v252, v230, v171
    v_xor_b32 v228, v230, v175
    v_xor_b32 v231, v230, v179
    v_or3_b32 v252, v252, v228, v231
    v_cmp_lt_u32 vcc, 0xffff, v252
    s_nop 4
    s_cbranch_vccnz L_rslow1
L_rback1:
    v_lshlrev_b32 v224, 16, v177
    v_and_b32 v225, s99, v177
    v_pk_add_f32 v[0:1], v[0:1], v[224:225]
    v_cvt_pk_bf16_f32 v20, v0, v1
    v_lshlrev_b32 v226, 16, v178
    v_and_b32 v227, s99, v178
    v_pk_add_f32 v[2:3], v[2:3], v[226:227]
    v_cvt_pk_bf16_f32 v21, v2, v3
    ds_write_b64 v234, v[20:21] offset:128
    v_add_u32 v234, s6, v234
    v_lshlrev_b32 v224, 16, v170
    v_and_b32 v225, s99, v170
    v_pk_add_f32 v[4:5], v[4:5], v[224:225]
    v_cvt_pk_bf16_f32 v24, v4, v5
    v_lshlrev_b32 v226, 16, v171
    v_lshlrev_b32 v227, 16, v172
    v_pk_add_f32 v[6:7], v[6:7], v[226:227]
    v_cvt_pk_bf16_f32 v25, v6, v7
    ds_write_b64 v234, v[24:25] offset:0
    v_and_b32 v224, s99, v174
    v_lshlrev_b32 v225, 16, v175
    v_pk_add_f32 v[12:13], v[12:13], v[224:225]
    v_cvt_pk_bf16_f32 v26, v12, v13
    v_lshlrev_b32 v226, 16, v176
    v_and_b32 v227, s99, v176
    v_pk_add_f32 v[14:15], v[14:15], v[226:227]
    v_cvt_pk_bf16_f32 v27, v14, v15
    ds_write_b64 v234, v[26:27] offset:32
    v_lshlrev_b32 v224, 16, v168
    v_and_b32 v225, s99, v168
    v_pk_add_f32 v[8:9], v[8:9], v[224:225]
    v_cvt_pk_bf16_f32 v28, v8, v9
    v_lshlrev_b32 v226, 16, v169
    v_and_b32 v227, s99, v169
    v_pk_add_f32 v[10:11], v[10:11], v[226:227]
    v_cvt_pk_bf16_f32 v29, v10, v11
    ds_write_b64 v234, v[28:29] offset:3328
    v_and_b32 v224, s99, v172
    v_lshlrev_b32 v225, 16, v173
    v_pk_add_f32 v[16:17], v[16:17], v[224:225]
    v_cvt_pk_bf16_f32 v30, v16, v17
    v_and_b32 v226, s99, v173
    v_lshlrev_b32 v227, 16, v174
    v_pk_add_f32 v[18:19], v[18:19], v[226:227]
    v_cvt_pk_bf16_f32 v31, v18, v19
    ds_write_b64 v234, v[30:31] offset:3360
    s_waitcnt lgkmcnt(0)
    s_barrier
    ds_read_b128 v[32:35], v235
    ds_read_b128 v[36:39], v235 offset:1664
    ds_read_b128 v[40:43], v237 offset:128
    s_waitcnt lgkmcnt(2)
    buffer_store_dwordx4 v[32:35], v241, s[28:31], s73 offen sc1
    s_waitcnt lgkmcnt(1)
    buffer_store_dwordx4 v[36:39], v241, s[28:31], s75 offen sc1
    s_waitcnt lgkmcnt(0)
    buffer_store_dwordx4 v[40:43], v242, s[28:31], s97 offen sc1
L_end:
    s_endpgm
L_nslow:
    s_mov_b32 s7, 0
L_nloop:
    s_sleep 2
    buffer_load_dwordx2 v[230:231], v255, s[32:35], s98 offen sc1
    s_waitcnt vmcnt(0)
    v_cmp_eq_u64 vcc, 0, v[230:231]
    s_nop 4
    s_cbranch_vccz L_nback
    s_add_u32 s7, s7, 1
    s_cmp_lt_u32 s7, 20000
    s_cbranch_scc1 L_nloop
    s_branch L_nback
L_pslow2:
    s_mov_b32 s7, 0
    s_lshl_b32 s3, s78, 11
    s_sub_u32 s3, s92, s3
    s_add_u32 s3, s3, s42
L_ploop2:
    buffer_load_dwordx4 v[208:211], v232, s[36:39], s3 offen offset:0 sc1
    buffer_load_dwordx4 v[212:215], v232, s[36:39], s3 offen offset:1024 sc1
    buffer_load_dwordx4 v[216:219], v232, s[36:39], s3 offen offset:2048 sc1
    buffer_load_dwordx4 v[220:223], v232, s[36:39], s3 offen offset:3072 sc1
    s_waitcnt vmcnt(0)
    v_xor_b32 v208, v224, v208
    v_xor_b32 v210, v225, v210
    v_or_b32 v252, v208, v210
    v_xor_b32 v212, v224, v212
    v_xor_b32 v214, v225, v214
    v_or3_b32 v252, v252, v212, v214
    v_xor_b32 v216, v224, v216
    v_xor_b32 v218, v225, v218
    v_or3_b32 v252, v252, v216, v218
    v_xor_b32 v220, v224, v220
    v_xor_b32 v222, v225, v222
    v_or3_b32 v252, v252, v220, v222
    v_and_b32 v252, 0xc000c000, v252
    v_cmp_ne_u32 vcc, 0, v252
    s_nop 4
    s_cbranch_vccz L_pback2
    s_sleep 4
    s_add_u32 s7, s7, 1
    s_cmp_lt_u32 s7, 20000
    s_cbranch_scc1 L_ploop2
    s_branch L_pback2
L_pslow3:
    s_mov_b32 s7, 0
    s_lshl_b32 s3, s78, 11
    s_sub_u32 s3, s92, s3
    s_add_u32 s3, s3, s43
L_ploop3:
    buffer_load_dwordx4 v[208:211], v232, s[36:39], s3 offen offset:0 sc1
    buffer_load_dwordx4 v[212:215], v232, s[36:39], s3 offen offset:1024 sc1
    buffer_load_dwordx4 v[216:219], v232, s[36:39], s3 offen offset:2048 sc1
    buffer_load_dwordx4 v[220:223], v232, s[36:39], s3 offen offset:3072 sc1
    s_waitcnt vmcnt(0)
    v_xor_b32 v208, v224, v208
    v_xor_b32 v210, v225, v210
    v_or_b32 v252, v208, v210
    v_xor_b32 v212, v224, v212
    v_xor_b32 v214, v225, v214
    v_or3_b32 v252, v252, v212, v214
    v_xor_b32 v216, v224, v216
    v_xor_b32 v218, v225, v218
    v_or3_b32 v252, v252, v216, v218
    v_xor_b32 v220, v224, v220
    v_xor_b32 v222, v225, v222
    v_or3_b32 v252, v252, v220, v222
    v_and_b32 v252, 0xc000c000, v252
    v_cmp_ne_u32 vcc, 0, v252
    s_nop 4
    s_cbranch_vccz L_pback3
    s_sleep 4
    s_add_u32 s7, s7, 1
    s_cmp_lt_u32 s7, 20000
    s_cbranch_scc1 L_ploop3
    s_branch L_pback3
L_pslow4:
    s_mov_b32 s7, 0
    s_lshl_b32 s3, s78, 11
    s_sub_u32 s3, s92, s3
    s_add_u32 s3, s3, s44
L_ploop4:
    buffer_load_dwordx4 v[208:211], v232, s[36:39], s3 offen offset:0 sc1
    buffer_load_dwordx4 v[212:215], v232, s[36:39], s3 offen offset:1024 sc1
    buffer_load_dwordx4 v[216:219], v232, s[36:39], s3 offen offset:2048 sc1
    buffer_load_dwordx4 v[220:223], v232, s[36:39], s3 offen offset:3072 sc1
    s_waitcnt vmcnt(0)
    v_xor_b32 v208, v224, v208
    v_xor_b32 v210, v225, v210
    v_or_b32 v252, v208, v210
    v_xor_b32 v212, v224, v212
    v_xor_b32 v214, v225, v214
    v_or3_b32 v252, v252, v212, v214
    v_xor_b32 v216, v224, v216
    v_xor_b32 v218, v225, v218
    v_or3_b32 v252, v252, v216, v218
    v_xor_b32 v220, v224, v220
    v_xor_b32 v222, v225, v222
    v_or3_b32 v252, v252, v220, v222
    v_and_b32 v252, 0xc000c000, v252
    v_cmp_ne_u32 vcc, 0, v252
    s_nop 4
    s_cbranch_vccz L_pback4
    s_sleep 4
    s_add_u32 s7, s7, 1
    s_cmp_lt_u32 s7, 20000
    s_cbranch_scc1 L_ploop4
    s_branch L_pback4
L_pslow5_1:
    s_mov_b32 s7, 0
    s_lshl_b32 s3, s78, 11
    s_sub_u32 s3, s92, s3
    s_add_u32 s3, s3, s45
L_ploop5_1:
    buffer_load_dwordx4 v[216:219], v232, s[36:39], s3 offen offset:2048 sc1
    buffer_load_dwordx4 v[220:223], v232, s[36:39], s3 offen offset:3072 sc1
    s_waitcnt vmcnt(0)
    v_xor_b32 v216, v224, v216
    v_xor_b32 v218, v225, v218
    v_or_b32 v252, v216, v218
    v_xor_b32 v220, v224, v220
    v_xor_b32 v222, v225, v222
    v_or3_b32 v252, v252, v220, v222
    v_and_b32 v252, 0xc000c000, v252
    v_cmp_ne_u32 vcc, 0, v252
    s_nop 4
    s_cbranch_vccz L_pback5_1
    s_sleep 4
    s_add_u32 s7, s7, 1
    s_cmp_lt_u32 s7, 20000
    s_cbranch_scc1 L_ploop5_1
    s_branch L_pback5_1
L_pslow6_1:
    s_mov_b32 s7, 0
    s_lshl_b32 s3, s78, 11
    s_sub_u32 s3, s92, s3
    s_add_u32 s3, s3, s46
L_ploop6_1:
    buffer_load_dwordx4 v[120:123], v232, s[36:39], s3 offen offset:2048 sc1
    buffer_load_dwordx4 v[124:127], v232, s[36:39], s3 offen offset:3072 sc1
    s_waitcnt vmcnt(0)
    v_xor_b32 v120, v224, v120
    v_xor_b32 v122, v225, v122
    v_or_b32 v252, v120, v122
    v_xor_b32 v124, v224, v124
    v_xor_b32 v126, v225, v126
    v_or3_b32 v252, v252, v124, v126
    v_and_b32 v252, 0xc000c000, v252
    v_cmp_ne_u32 vcc, 0, v252
    s_nop 4
    s_cbranch_vccz L_pback6_1
    s_sleep 4
    s_add_u32 s7, s7, 1
    s_cmp_lt_u32 s7, 20000
    s_cbranch_scc1 L_ploop6_1
    s_branch L_pback6_1
L_pslow7_1:
    s_mov_b32 s7, 0
    s_lshl_b32 s3, s78, 11
    s_sub_u32 s3, s92, s3
    s_add_u32 s3, s3, s47
L_ploop7_1:
    buffer_load_dwordx4 v[216:219], v232, s[36:39], s3 offen offset:2048 sc1
    buffer_load_dwordx4 v[220:223], v232, s[36:39], s3 offen offset:3072 sc1
    s_waitcnt vmcnt(0)
    v_xor_b32 v216, v224, v216
    v_xor_b32 v218, v225, v218
    v_or_b32 v252, v216, v218
    v_xor_b32 v220, v224, v220
    v_xor_b32 v222, v225, v222
    v_or3_b32 v252, v252, v220, v222
    v_and_b32 v252, 0xc000c000, v252
    v_cmp_ne_u32 vcc, 0, v252
    s_nop 4
    s_cbranch_vccz L_pback7_1
    s_sleep 4
    s_add_u32 s7, s7, 1
    s_cmp_lt_u32 s7, 20000
    s_cbranch_scc1 L_ploop7_1
    s_branch L_pback7_1
L_pslow5_0:
    s_mov_b32 s7, 0
    s_lshl_b32 s3, s78, 11
    s_sub_u32 s3, s92, s3
    s_add_u32 s3, s3, s45
L_ploop5_0:
    buffer_load_dwordx4 v[208:211], v232, s[36:39], s3 offen offset:0 sc1
    buffer_load_dwordx4 v[212:215], v232, s[36:39], s3 offen offset:1024 sc1
    s_waitcnt vmcnt(0)
    v_xor_b32 v208, v224, v208
    v_xor_b32 v210, v225, v210
    v_or_b32 v252, v208, v210
    v_xor_b32 v212, v224, v212
    v_xor_b32 v214, v225, v214
    v_or3_b32 v252, v252, v212, v214
    v_and_b32 v252, 0xc000c000, v252
    v_cmp_ne_u32 vcc, 0, v252
    s_nop 4
    s_cbranch_vccz L_pback5_0
    s_sleep 4
    s_add_u32 s7, s7, 1
    s_cmp_lt_u32 s7, 20000
    s_cbranch_scc1 L_ploop5_0
    s_branch L_pback5_0
L_pslow6_0:
    s_mov_b32 s7, 0
    s_lshl_b32 s3, s78, 11
    s_sub_u32 s3, s92, s3
    s_add_u32 s3, s3, s46
L_ploop6_0:
    buffer_load_dwordx4 v[120:123], v232, s[36:39], s3 offen offset:0 sc1
    buffer_load_dwordx4 v[124:127], v232, s[36:39], s3 offen offset:1024 sc1
    s_waitcnt vmcnt(0)
    v_xor_b32 v120, v224, v120
    v_xor_b32 v122, v225, v122
    v_or_b32 v252, v120, v122
    v_xor_b32 v124, v224, v124
    v_xor_b32 v126, v225, v126
    v_or3_b32 v252, v252, v124, v126
    v_and_b32 v252, 0xc000c000, v252
    v_cmp_ne_u32 vcc, 0, v252
    s_nop 4
    s_cbranch_vccz L_pback6_0
    s_sleep 4
    s_add_u32 s7, s7, 1
    s_cmp_lt_u32 s7, 20000
    s_cbranch_scc1 L_ploop6_0
    s_branch L_pback6_0
L_pslow7_0:
    s_mov_b32 s7, 0
    s_lshl_b32 s3, s78, 11
    s_sub_u32 s3, s92, s3
    s_add_u32 s3, s3, s47
L_ploop7_0:
    buffer_load_dwordx4 v[216:219], v232, s[36:39], s3 offen offset:0 sc1
    buffer_load_dwordx4 v[220:223], v232, s[36:39], s3 offen offset:1024 sc1
    s_waitcnt vmcnt(0)
    v_xor_b32 v216, v224, v216
    v_xor_b32 v218, v225, v218
    v_or_b32 v252, v216, v218
    v_xor_b32 v220, v224, v220
    v_xor_b32 v222, v225, v222
    v_or3_b32 v252, v252, v220, v222
    v_and_b32 v252, 0xc000c000, v252
    v_cmp_ne_u32 vcc, 0, v252
    s_nop 4
    s_cbranch_vccz L_pback7_0
    s_sleep 4
    s_add_u32 s7, s7, 1
    s_cmp_lt_u32 s7, 20000
    s_cbranch_scc1 L_ploop7_0
    s_branch L_pback7_0
L_rslow3:
    s_mov_b32 s7, 0
L_rp3_0:
    v_xor_b32 v252, v230, v195
    v_cmp_lt_u32 vcc, 0xffff, v252
    s_nop 4
    s_cbranch_vccz L_rp3_1
    buffer_load_dwordx4 v[192:195], v232, s[36:39], s5 offen offset:0 sc1
    buffer_load_dwordx4 v[196:199], v232, s[36:39], s5 offen offset:1024 sc1
    buffer_load_dwordx4 v[200:203], v232, s[36:39], s5 offen offset:2048 sc1
    s_waitcnt vmcnt(0)
    s_add_u32 s7, s7, 1
    s_cmp_lt_u32 s7, 20000
    s_cbranch_scc1 L_rp3_0
    s_branch L_rback3
L_rp3_1:
    v_xor_b32 v252, v230, v199
    v_cmp_lt_u32 vcc, 0xffff, v252
    s_nop 4
    s_cbranch_vccz L_rp3_2
    buffer_load_dwordx4 v[196:199], v232, s[36:39], s5 offen offset:1024 sc1
    buffer_load_dwordx4 v[200:203], v232, s[36:39], s5 offen offset:2048 sc1
    s_waitcnt vmcnt(0)
    s_add_u32 s7, s7, 1
    s_cmp_lt_u32 s7, 20000
    s_cbranch_scc1 L_rp3_1
    s_branch L_rback3
L_rp3_2:
    v_xor_b32 v252, v230, v203
    v_cmp_lt_u32 vcc, 0xffff, v252
    s_nop 4
    s_cbranch_vccz L_rback3
    buffer_load_dwordx4 v[200:203], v232, s[36:39], s5 offen offset:2048 sc1
    s_waitcnt vmcnt(0)
    s_add_u32 s7, s7, 1
    s_cmp_lt_u32 s7, 20000
    s_cbranch_scc1 L_rp3_2
    s_branch L_rback3
L_rslow2:
    s_mov_b32 s7, 0
L_rp2_0:
    v_xor_b32 v252, v230, v183
    v_cmp_lt_u32 vcc, 0xffff, v252
    s_nop 4
    s_cbranch_vccz L_rp2_1
    buffer_load_dwordx4 v[180:183], v232, s[36:39], s4 offen offset:0 sc1
    buffer_load_dwordx4 v[184:187], v232, s[36:39], s4 offen offset:1024 sc1
    buffer_load_dwordx4 v[188:191], v232, s[36:39], s4 offen offset:2048 sc1
    s_waitcnt vmcnt(0)
    s_add_u32 s7, s7, 1
    s_cmp_lt_u32 s7, 20000
    s_cbranch_scc1 L_rp2_0
    s_branch L_rback2
L_rp2_1:
    v_xor_b32 v252, v230, v187
    v_cmp_lt_u32 vcc, 0xffff, v252
    s_nop 4
    s_cbranch_vccz L_rp2_2
    buffer_load_dwordx4 v[184:187], v232, s[36:39], s4 offen offset:1024 sc1
    buffer_load_dwordx4 v[188:191], v232, s[36:39], s4 offen offset:2048 sc1
    s_waitcnt vmcnt(0)
    s_add_u32 s7, s7, 1
    s_cmp_lt_u32 s7, 20000
    s_cbranch_scc1 L_rp2_1
    s_branch L_rback2
L_rp2_2:
    v_xor_b32 v252, v230, v191
    v_cmp_lt_u32 vcc, 0xffff, v252
    s_nop 4
    s_cbranch_vccz L_rback2
    buffer_load_dwordx4 v[188:191], v232, s[36:39], s4 offen offset:2048 sc1
    s_waitcnt vmcnt(0)
    s_add_u32 s7, s7, 1
    s_cmp_lt_u32 s7, 20000
    s_cbranch_scc1 L_rp2_2
    s_branch L_rback2
L_rslow1:
    s_mov_b32 s7, 0
L_rp1_0:
    v_xor_b32 v252, v230, v171
    v_cmp_lt_u32 vcc, 0xffff, v252
    s_nop 4
    s_cbranch_vccz L_rp1_1
    buffer_load_dwordx4 v[168:171], v232, s[36:39], s96 offen offset:0 sc1
    buffer_load_dwordx4 v[172:175], v232, s[36:39], s96 offen offset:1024 sc1
    buffer_load_dwordx4 v[176:179], v232, s[36:39], s96 offen offset:2048 sc1
    s_waitcnt vmcnt(0)
    s_add_u32 s7, s7, 1
    s_cmp_lt_u32 s7, 20000
    s_cbranch_scc1 L_rp1_0
    s_branch L_rback1
L_rp1_1:
    v_xor_b32 v252, v230, v175
    v_cmp_lt_u32 vcc, 0xffff, v252
    s_nop 4
    s_cbranch_vccz L_rp1_2
    buffer_load_dwordx4 v[172:175], v232, s[36:39], s96 offen offset:1024 sc1
    buffer_load_dwordx4 v[176:179], v232, s[36:39], s96 offen offset:2048 sc1
    s_waitcnt vmcnt(0)
    s_add_u32 s7, s7, 1
    s_cmp_lt_u32 s7, 20000
    s_cbranch_scc1 L_rp1_1
    s_branch L_rback1
L_rp1_2:
    v_xor_b32 v252, v230, v179
    v_cmp_lt_u32 vcc, 0xffff, v252
    s_nop 4
    s_cbranch_vccz L_rback1
    buffer_load_dwordx4 v[176:179], v232, s[36:39], s96 offen offset:2048 sc1
    s_waitcnt vmcnt(0)
    s_add_u32 s7, s7, 1
    s_cmp_lt_u32 s7, 20000
    s_cbranch_scc1 L_rp1_2
    s_branch L_rback1
L_last:
    s_endpgm
.section .rodata,"a"
.p2align 6
.amdhsa_kernel concat_heads__gqa_block_cached__gqa_block_cached__near_ridge_kernel
  .amdhsa_next_free_vgpr 512
  .amdhsa_next_free_sgpr 102
  .amdhsa_accum_offset 256
  .amdhsa_group_segment_fixed_size 0
  .amdhsa_kernarg_size 104
  .amdhsa_user_sgpr_count 2
  .amdhsa_user_sgpr_kernarg_segment_ptr 1
  .amdhsa_system_sgpr_workgroup_id_x 1
  .amdhsa_float_denorm_mode_32 3
  .amdhsa_float_denorm_mode_16_64 3
.end_amdhsa_kernel
```
